```python
import torch

def _softmax(x, axis=-1):
    return torch.softmax(x, dim=axis)

def _gelu(x):
    return torch.nn.functional.gelu(x, approximate='tanh')

def _silu(x):
    return torch.nn.functional.silu(x)

def _sigmoid(x):
    return torch.sigmoid(x)

def _layernorm(x, axis=-1, eps=1e-05):
    m = x.mean(dim=axis, keepdim=True)
    v = x.var(dim=axis, keepdim=True, unbiased=False)
    return (x - m) / torch.sqrt(v + eps)

def _scatter_add(tgt, idx, src, axis=0):
    return tgt.clone().index_add_(axis, idx, src)

def _segment_sum(src, seg, n):
    out = torch.zeros((n,) + src.shape[1:], dtype=src.dtype)
    return out.index_add_(0, seg, src)

def _pad(x, pw):
    flat = tuple((v for pair in reversed(pw) for v in pair))
    return torch.nn.functional.pad(x, flat)
kernel_name = 'adaLN_cond__ssm_conv_h3__dense_activation_relu__prompt'

def setup_inputs():

    _w = lambda a: (lambda t: t.to(torch.bfloat16) if t.is_floating_point() else t)(torch.as_tensor(a))

    def _A_setup():
        B, S, D = (1, 2048, 512)
        ks = 4
        return {'q': _w((lambda *s: torch.randn(*s, dtype=torch.bfloat16) * 0.05)(B, S, D)), 'k': _w((lambda *s: torch.randn(*s, dtype=torch.bfloat16) * 0.8)(B, S, D)), 'v': _w((lambda *s: torch.randn(*s, dtype=torch.bfloat16) * 0.8)(B, S, D)), 'shift_k': _w((lambda *s: torch.randn(*s, dtype=torch.bfloat16) * 0.8)(D, ks) * 0.5), 'ssm_k': _w((lambda *s: torch.randn(*s, dtype=torch.bfloat16) * 0.8)(D, S) * (1.0 / S ** 0.5)), 'ssm_D': _w((lambda *s: torch.randn(*s, dtype=torch.bfloat16) * 0.8)(D))}
    _A_in = _A_setup()

    def _B_setup():
        B, S, D, Dff = (1, 2048, 512, 1376)
        return {'x': _w((lambda *s: torch.randn(*s, dtype=torch.bfloat16) * 0.05)(B, S, D)), 'w1': _w((lambda *s: torch.randn(*s, dtype=torch.bfloat16) * 0.05)(D, Dff)), 'w2': _w((lambda *s: torch.randn(*s, dtype=torch.bfloat16) * 0.05)(Dff, D))}
    _B_in = _B_setup()
    return {'A_q': _A_in['q'], 'A_k': _A_in['k'], 'A_v': _A_in['v'], 'A_shift_k': _A_in['shift_k'], 'A_ssm_k': _A_in['ssm_k'], 'A_ssm_D': _A_in['ssm_D'], 'B_x': _B_in['x'], 'B_w1': _B_in['w1'], 'B_w2': _B_in['w2'], 'c': _w((lambda *s: torch.randn(*s, dtype=torch.bfloat16) * 0.2)(1, 512) * 8.0), 'w_mod': _w((lambda *s: torch.randn(*s, dtype=torch.bfloat16) * 0.2)(512, 6 * 512) * 512 ** (-0.5) * 8.0)}

def reference(A_q, A_k, A_v, A_shift_k, A_ssm_k, A_ssm_D, B_x, B_w1, B_w2, c, w_mod):

    def _A_ref(q, k, v, shift_k, ssm_k, ssm_D):
        B, S, D = q.shape
        ks = shift_k.shape[-1]
        k_pad = _pad(k, ((0, 0), (ks - 1, 0), (0, 0)))
        k_shift = torch.zeros_like(k)
        for t in range(ks):
            k_shift = k_shift + k_pad[:, t:t + S, :] * shift_k[:, ks - 1 - t][None, None, :]
        kv = k_shift * v
        L = 2 * S
        kv_pad = _pad(kv, ((0, 0), (0, S), (0, 0)))
        kf_pad = _pad(ssm_k, ((0, 0), (0, S)))
        kv_f = (lambda x, axes=(-2, -1): torch.fft.rfft2(x.float(), dim=axes))(kv_pad[:, None, :, :], axes=(1, 2))
        kf_f = (lambda x, axes=(-2, -1): torch.fft.rfft2(x.float(), dim=axes))(kf_pad[:, None, :], axes=(1, 2))
        kf_f = (lambda x, *d: x.permute(*d))(kf_f, 1, 2, 0)
        y_f = kv_f * kf_f[None, :, :, :]
        y = (lambda x, s, axes=(-2, -1): torch.fft.irfft2(x, s=s, dim=axes).to(torch.bfloat16))(y_f, (1, L), axes=(1, 2))[:, 0, :S, :]
        y = y + kv * ssm_D[None, None, :]
        return q * y

    def _B_ref(x, w1, w2):
        h = torch.einsum('bsd,df->bsf', x, w1)
        zero = torch.zeros_like(h)
        h = torch.maximum(h, zero)
        return torch.einsum('bsf,fd->bsd', h, w2)
    x = A_q
    mod = (_silu(c) @ w_mod).reshape(c.shape[0], 6, 1, -1)
    sa, ca, ga, sb, cb, gb = (mod[:, 0].clone(), mod[:, 1].clone(), mod[:, 2].clone(), mod[:, 3].clone(), mod[:, 4].clone(), mod[:, 5].clone())
    h = _layernorm(x, axis=-1) * (1 + ca) + sa
    x = x + ga * _A_ref(h, A_k, A_v, A_shift_k, A_ssm_k, A_ssm_D)
    h = _layernorm(x, axis=-1) * (1 + cb) + sb
    x = x + gb * _B_ref(h, B_w1, B_w2)
    return x
```

```asm
; @launch grid=(256,1,1) block=(256,1,1) lds=157280
.amdgcn_target "amdgcn-amd-amdhsa--gfx950"
.text
.globl adaLN_cond__ssm_conv_h3__dense_activation_relu__prompt_kernel
.p2align 8
.type adaLN_cond__ssm_conv_h3__dense_activation_relu__prompt_kernel,@function
adaLN_cond__ssm_conv_h3__dense_activation_relu__prompt_kernel:
    s_cmp_ge_u32 s2, 256
    s_cbranch_scc1 L_exit
    s_load_dwordx2 s[4:5], s[0:1], 8
    s_load_dwordx2 s[8:9], s[0:1], 16
    s_load_dwordx2 s[40:41], s[0:1], 24
    s_load_dwordx2 s[36:37], s[0:1], 104
    s_getpc_b64 s[62:63]
    s_and_b32 s50, s2, 0xf8
    v_and_b32 v4, 7, v0
    v_add_lshl_u32 v4, v4, s50, 7
    v_min_u32 v4, L_exit-adaLN_cond__ssm_conv_h3__dense_activation_relu__prompt_kernel-64, v4
    global_load_dword v255, v4, s[62:63]
    v_lshrrev_b32 v4, 6, v0
    v_and_b32 v1, 63, v0
    v_readfirstlane_b32 s48, v4
    v_and_b32 v2, 15, v0
    v_lshrrev_b32 v3, 4, v1
    v_and_b32 v36, 3, v0
    s_and_b32 s49, s2, 7
    s_lshr_b32 s50, s2, 3
    s_mov_b32 s6, 2097152
    s_mov_b32 s7, 0x20000
    s_mov_b32 s10, 2097152
    s_mov_b32 s11, 0x20000
    v_and_b32 v4, 12, v0
    v_and_b32 v5, 1, v3
    v_lshlrev_b32 v4, 9, v4
    v_lshl_add_u32 v4, v5, 10, v4
    v_lshrrev_b32 v5, 5, v1
    v_lshl_add_u32 v4, v5, 6, v4
    v_lshl_add_u32 v4, v36, 4, v4
    s_lshl_b32 s60, s50, 16
    s_lshl_b32 s55, s49, 7
    s_add_u32 s60, s60, s55
    s_sub_u32 s54, s60, 4096
    s_lshl_b32 s55, s48, 14
    s_add_u32 s55, s55, s54
    v_add_u32 v39, s55, v4
    v_add_u32 v40, 0x2000, v39
    v_add_u32 v42, 0x1000, v39
    v_add_u32 v43, 0x3000, v39
    s_add_u32 s54, s54, 0x10000
    v_add_u32 v41, s54, v4
    s_lshr_b32 s75, s48, 1
    s_and_b32 s71, s48, 1
    s_lshl_b32 s57, s49, 9
    s_lshl_b32 s58, s75, 8
    s_add_u32 s57, s57, s58
    v_lshl_add_u32 v5, v36, 6, s57
    s_lshl_b32 s74, s48, 11
    s_lshl_b32 s58, s71, 4
    s_lshl_b32 s59, s75, 2
    s_add_u32 s58, s58, s59
    s_lshl_b32 s58, 15, s58
    s_add_u32 m0, s74, 81920
    s_waitcnt lgkmcnt(0)
    global_load_dwordx4 v[230:233], v5, s[40:41] offset:0
    global_load_dwordx4 v[234:237], v5, s[40:41] offset:16
    global_load_dwordx4 v[238:241], v5, s[40:41] offset:32
    global_load_dwordx4 v[242:245], v5, s[40:41] offset:48
    buffer_load_dwordx4 v39, s[4:7], 0 offen lds
    s_add_u32 m0, s74, 82944
    s_nop 0
    buffer_load_dwordx4 v40, s[4:7], 0 offen lds
    s_add_u32 m0, s74, 91136
    s_nop 0
    buffer_load_dwordx4 v42, s[8:11], 0 offen lds
    s_add_u32 m0, s74, 92160
    s_nop 0
    buffer_load_dwordx4 v43, s[8:11], 0 offen lds
    s_mov_b32 m0, 90112
    s_mov_b32 exec_lo, s58
    s_mov_b32 exec_hi, s58
    buffer_load_dwordx4 v41, s[4:7], 0 offen lds
    s_mov_b64 exec, -1
    s_load_dwordx2 s[16:17], s[0:1], 32
    s_load_dwordx2 s[42:43], s[0:1], 72
    s_load_dwordx2 s[46:47], s[0:1], 96
    s_load_dwordx2 s[12:13], s[0:1], 0
    s_load_dwordx2 s[44:45], s[0:1], 40
    s_load_dwordx2 s[20:21], s[0:1], 56
    s_load_dwordx2 s[24:25], s[0:1], 64
    s_load_dwordx2 s[28:29], s[0:1], 80
    s_load_dwordx2 s[32:33], s[0:1], 88
    s_mov_b32 s18, 4096
    s_mov_b32 s19, 0x20000
    s_or_b32 s58, s2, s48
    s_cmp_lg_u32 s58, 0
    s_cbranch_scc1 L_nonce_1
    s_memrealtime s[64:65]
    s_waitcnt lgkmcnt(0)
    s_or_b32 s58, s64, 1
    s_mov_b64 exec, 1
    v_mov_b32 v4, s58
    global_store_dword v1, v4, s[46:47] sc1
    s_mov_b64 exec, -1
L_nonce_1:
    s_lshl_b32 s70, s49, 6
    s_lshl_b32 s58, s50, 1
    s_add_u32 s70, s70, s58
    s_lshl_b32 s58, s70, 1
    s_waitcnt lgkmcnt(0)
    s_load_dword s53, s[44:45], s58
    s_add_u32 s70, s70, s75
    s_lshl_b32 s58, s70, 12
    s_add_u32 s16, s16, s58
    s_addc_u32 s17, s17, 0
    v_lshlrev_b32 v6, 4, v1
    s_lshl_b32 s57, s71, 11
    v_add_u32 v23, s57, v6
    s_mul_i32 s59, s75, 4112
    s_add_u32 s59, s59, 107520
    s_add_u32 s58, s59, s57
    s_add_u32 m0, s58, 16
    v_lshlrev_b32 v4, 2, v0
    buffer_load_dwordx4 v23, s[16:19], 0 offen lds
    buffer_load_dwordx4 v23, s[16:19], 0 offen offset:1024 lds
    global_load_dword v41, v4, s[42:43]
    s_mov_b32 s14, 2097152
    s_mov_b32 s15, 0x20000
    s_mov_b32 s22, 1409024
    s_mov_b32 s23, 0x20000
    v_lshrrev_b32 v44, 2, v2
    v_xor_b32 v4, v44, v3
    s_lshl_b32 s58, s2, 2
    v_add_u32 v5, s58, v4
    v_mul_u32_u24 v34, 1525, v5
    v_lshrrev_b32 v34, 16, v34
    v_mul_u32_u24 v35, 43, v34
    v_sub_u32 v5, v5, v35
    v_lshl_add_u32 v34, v34, 5, v3
    v_lshl_add_u32 v34, s48, 3, v34
    v_mul_u32_u24 v34, 2752, v34
    v_lshl_add_u32 v34, v5, 6, v34
    v_lshl_add_u32 v42, v36, 4, v34
    s_add_u32 m0, s74, 132352
    s_movk_i32 s54, 11008
    buffer_load_dwordx4 v42, s[20:23], 0 offen lds
    s_add_u32 m0, s74, 133376
    s_nop 0
    buffer_load_dwordx4 v42, s[20:23], s54 offen lds
    s_lshl_b32 s54, s50, 6
    s_lshl_b32 s55, s49, 3
    s_add_u32 s54, s54, s55
    s_lshl_b32 s55, s48, 1
    s_add_u32 s54, s54, s55
    s_lshl_b32 s55, s54, 10
    v_and_b32 v4, 0x200, v6
    v_add3_u32 v43, v4, v6, s55
    buffer_load_dwordx4 v[222:225], v43, s[12:15], 0 offen
    buffer_load_dwordx4 v[226:229], v43, s[12:15], 0 offen offset:512
    s_bfe_u32 s56, s54, 0x30002
    s_lshl_b32 s56, s56, 10
    s_lshr_b32 s57, s54, 5
    s_lshl_b32 s57, s57, 4
    s_add_u32 s56, s56, s57
    s_and_b32 s57, s54, 3
    s_lshl_b32 s57, s57, 2
    s_add_u32 s56, s56, s57
    s_add_u32 s56, s56, 98304
    v_lshrrev_b32 v4, 5, v1
    v_lshl_add_u32 v45, v4, 2, s56
    v_add_u32 v46, 8192, v45
    s_mov_b32 s51, 0xffff0000
    s_mov_b32 s26, 1409024
    s_mov_b32 s27, 0x20000
    s_mov_b32 s30, 3145728
    s_mov_b32 s31, 0x20000
    s_mov_b32 s34, 2097152
    s_mov_b32 s35, 0x20000
    s_mov_b32 s38, 16777216
    s_mov_b32 s39, 0x20000
    v_add_u32 v40, s59, v23
    v_mov_b32 v48, 0
    v_mov_b32 v49, 0
    v_mov_b32 v50, 0
    v_mov_b32 v51, 0
    v_mov_b32 v4, s59
    ds_write_b128 v4, v[48:51]
    v_mov_b32 v4, 156928
    ds_write_b128 v4, v[48:51]
    ds_write_b128 v4, v[48:51] offset:16
    s_cmp_ge_u32 s48, 2
    s_cbranch_scc1 L_zf_2
    v_lshrrev_b32 v4, 4, v0
    v_mul_u32_u24 v4, 1280, v4
    v_lshl_add_u32 v4, v2, 4, v4
    v_add_u32 v4, 66560, v4
    s_branch L_zd_3
L_zf_2:
    v_lshrrev_b32 v4, 2, v1
    v_mul_u32_u24 v4, 4160, v4
    v_min_u32 v5, 2, v36
    v_lshl_add_u32 v4, v5, 4, v4
L_zd_3:
    ds_write_b128 v4, v[48:51]
    s_lshl_b32 s55, s71, 4
    s_lshl_b32 s57, s75, 9
    s_add_u32 s57, s57, 81920
    v_lshrrev_b32 v4, 2, v1
    v_lshl_add_u32 v34, v36, 4, s57
    v_add_u32 v5, s55, v4
    v_lshrrev_b32 v35, 2, v5
    v_and_b32 v5, 3, v5
    v_lshl_add_u32 v35, v35, 10, v34
    v_lshl_add_u32 v47, v5, 6, v35
    s_add_u32 s55, s55, 1
    v_add_u32 v5, s55, v4
    v_lshrrev_b32 v35, 2, v5
    v_and_b32 v5, 3, v5
    v_lshl_add_u32 v35, v35, 10, v34
    v_lshl_add_u32 v48, v5, 6, v35
    s_add_u32 s55, s55, 1
    v_add_u32 v5, s55, v4
    v_lshrrev_b32 v35, 2, v5
    v_and_b32 v5, 3, v5
    v_lshl_add_u32 v35, v35, 10, v34
    v_lshl_add_u32 v49, v5, 6, v35
    s_add_u32 s55, s74, 148736
    v_and_b32 v54, 1, v3
    v_lshlrev_b32 v35, 1, v54
    v_xor_b32 v35, v35, v36
    v_lshl_add_u32 v35, v35, 4, s55
    v_lshl_add_u32 v50, v4, 7, v35
    v_lshl_add_u32 v53, v3, 3, v44
    v_lshl_add_u32 v35, v36, 3, s55
    v_lshl_add_u32 v35, v53, 6, v35
    v_lshl_add_u32 v51, v54, 5, v35
    v_xor_b32 v52, 32, v51
    v_lshlrev_b32 v4, 12, v2
    v_lshl_add_u32 v4, v3, 4, v4
    s_lshl_b32 s54, s49, 18
    s_lshl_b32 s55, s50, 7
    s_add_u32 s54, s54, s55
    s_lshl_b32 s55, s48, 16
    s_add_u32 s55, s55, s54
    s_add_u32 s55, s55, 3145728
    v_add_u32 v57, s55, v4
    s_lshl_b32 s55, s75, 17
    s_add_u32 s54, s54, s55
    s_lshl_b32 s55, s71, 6
    s_add_u32 s54, s54, s55
    s_add_u32 s54, s54, 1048576
    v_add_u32 v55, s54, v4
    v_add_u32 v56, 0x10000, v55
    s_lshl_b32 s3, s49, 5
    s_add_u32 s3, s3, s50
    s_mul_i32 s54, s75, 33280
    s_add_u32 s54, s54, 48
    v_add_u32 v39, s54, v23
    v_xor_b32 v4, v44, v3
    s_lshr_b32 s54, s2, 2
    s_lshl_b32 s54, s54, 15
    s_and_b32 s55, s2, 3
    s_lshl_b32 s55, s55, 8
    s_add_u32 s54, s54, s55
    s_lshl_b32 s55, s48, 13
    s_add_u32 s54, s54, s55
    v_lshl_add_u32 v35, v3, 10, s54
    v_lshl_add_u32 v35, v4, 6, v35
    v_lshl_add_u32 v58, v36, 4, v35
    v_and_b32 v4, 7, v0
    v_lshlrev_b32 v5, 1, v54
    v_xor_b32 v4, v4, v5
    v_lshlrev_b32 v4, 4, v4
    v_lshrrev_b32 v34, 3, v1
    s_lshl_b32 s54, s48, 14
    s_add_u32 s54, s54, s60
    v_lshl_add_u32 v5, v34, 10, v4
    v_add_u32 v59, s54, v5
    v_xor_b32 v60, 64, v59
    s_lshr_b32 s57, s50, 2
    s_lshl_b32 s57, s57, 3
    s_add_u32 s57, s57, s49
    s_and_b32 s58, s50, 3
    s_lshl_b32 s54, s58, 2
    s_add_u32 s54, s54, s48
    s_mul_i32 s54, s54, 196608
    s_lshl_b32 s55, s57, 7
    s_add_u32 s54, s54, s55
    s_cmp_lt_u32 s50, 24
    s_cselect_b32 s54, s54, 0x7f000000
    v_mul_u32_u24 v34, 6144, v34
    v_add3_u32 v61, v34, v4, s54
    v_xor_b32 v62, 64, v61
    s_mul_i32 s54, s58, 12288
    s_lshl_b32 s55, s57, 8
    s_add_u32 s54, s54, s55
    s_lshl_b32 s55, s48, 6
    s_add_u32 s54, s54, s55
    s_add_u32 s54, s54, 131072
    s_cmp_lt_u32 s50, 24
    s_cselect_b32 s54, s54, 0x7f000000
    s_cmp_lt_u32 s50, 12
    s_cselect_b32 s55, s54, 0x7f000000
    s_cselect_b32 s54, 0x7f000000, s54
    v_lshl_add_u32 v63, v3, 4, s55
    v_lshl_add_u32 v64, v3, 4, s54
    s_lshl_b32 s54, s58, 8
    s_add_u32 s54, s54, 76800
    v_lshl_add_u32 v65, v3, 4, s54
    s_lshl_b32 s54, s2, 2
    s_add_u32 s54, s54, s48
    s_mul_i32 s57, s54, 1525
    s_lshr_b32 s57, s57, 16
    s_mul_i32 s55, s57, 43
    s_sub_u32 s58, s54, s55
    v_xor_b32 v34, s48, v44
    v_lshlrev_b32 v34, 6, v34
    v_lshl_add_u32 v34, v53, 8, v34
    v_lshl_add_u32 v68, v36, 4, v34
    v_and_b32 v5, 1, v36
    v_lshl_add_u32 v34, v5, 4, v34
    v_lshrrev_b32 v5, 1, v36
    v_lshl_add_u32 v34, v5, 3, v34
    s_cmp_ge_u32 s58, 32
    s_cselect_b64 vcc, -1, 0
    s_cselect_b32 s56, 32, 8
    v_cndmask_b32 v66, v68, v34, vcc
    v_add_u32 v66, 132352, v66
    v_add_u32 v67, s56, v66
    v_add_u32 v68, 140544, v68
    s_mul_i32 s56, s58, 34
    s_add_u32 s56, s56, s57
    s_lshl_b32 s56, s56, 10
    s_add_u32 s56, s56, 7340032
    s_lshr_b32 s55, s54, 4
    s_bfe_u32 s59, s54, 0x30001
    s_mul_i32 s59, s59, 43
    s_add_u32 s55, s55, s59
    s_lshl_b32 s55, s55, 1
    s_add_u32 s55, s55, s71
    s_lshl_b32 s55, s55, 11
    s_add_u32 s55, s55, 8912896
    s_cmp_lt_u32 s2, 172
    s_cselect_b32 s56, s56, 0x7f000000
    s_cselect_b32 s55, s55, 0x7f000000
    v_add_u32 v69, s56, v6
    v_add_u32 v70, 17408, v69
    v_add_u32 v71, s55, v6
    s_waitcnt vmcnt(12)
    v_lshlrev_b32 v190, 16, v230
    v_lshlrev_b32 v191, 16, v232
    v_lshlrev_b32 v192, 16, v234
    v_lshlrev_b32 v193, 16, v236
    v_lshlrev_b32 v194, 16, v238
    v_lshlrev_b32 v195, 16, v240
    v_lshlrev_b32 v196, 16, v242
    v_lshlrev_b32 v197, 16, v244
    v_and_b32 v198, s51, v230
    v_and_b32 v199, s51, v232
    v_and_b32 v200, s51, v234
    v_and_b32 v201, s51, v236
    v_and_b32 v202, s51, v238
    v_and_b32 v203, s51, v240
    v_and_b32 v204, s51, v242
    v_and_b32 v205, s51, v244
    v_lshlrev_b32 v206, 16, v231
    v_lshlrev_b32 v207, 16, v233
    v_lshlrev_b32 v208, 16, v235
    v_lshlrev_b32 v209, 16, v237
    v_lshlrev_b32 v210, 16, v239
    v_lshlrev_b32 v211, 16, v241
    v_lshlrev_b32 v212, 16, v243
    v_lshlrev_b32 v213, 16, v245
    v_and_b32 v214, s51, v231
    v_and_b32 v215, s51, v233
    v_and_b32 v216, s51, v235
    v_and_b32 v217, s51, v237
    v_and_b32 v218, s51, v239
    v_and_b32 v219, s51, v241
    v_and_b32 v220, s51, v243
    v_and_b32 v221, s51, v245
    s_waitcnt vmcnt(7)
    s_waitcnt lgkmcnt(0)
    s_barrier
    ds_read_b128 v[170:173], v47 offset:256
    ds_read_b128 v[174:177], v48 offset:0
    ds_read_b128 v[178:181], v48 offset:256
    ds_read_b128 v[182:185], v49 offset:0
    ds_read_b128 v[186:189], v49 offset:256
    ds_read_b128 v[162:165], v47 offset:9216
    ds_read_b128 v[166:169], v47 offset:9472
    s_getreg_b32 s44, hwreg(HW_REG_XCC_ID, 0, 4)
    s_mov_b32 s45, 0
    s_waitcnt lgkmcnt(6)
    v_lshlrev_b32 v122, 16, v170
    v_and_b32 v123, s51, v170
    v_lshlrev_b32 v124, 16, v171
    v_and_b32 v125, s51, v171
    v_lshlrev_b32 v126, 16, v172
    v_and_b32 v127, s51, v172
    v_lshlrev_b32 v128, 16, v173
    v_and_b32 v129, s51, v173
    s_waitcnt lgkmcnt(5)
    v_lshlrev_b32 v130, 16, v174
    v_and_b32 v131, s51, v174
    v_lshlrev_b32 v132, 16, v175
    v_and_b32 v133, s51, v175
    v_lshlrev_b32 v134, 16, v176
    v_and_b32 v135, s51, v176
    v_lshlrev_b32 v136, 16, v177
    v_and_b32 v137, s51, v177
    s_waitcnt lgkmcnt(4)
    v_lshlrev_b32 v138, 16, v178
    v_and_b32 v139, s51, v178
    v_lshlrev_b32 v140, 16, v179
    v_and_b32 v141, s51, v179
    v_lshlrev_b32 v142, 16, v180
    v_and_b32 v143, s51, v180
    v_lshlrev_b32 v144, 16, v181
    v_and_b32 v145, s51, v181
    s_waitcnt lgkmcnt(3)
    v_lshlrev_b32 v146, 16, v182
    v_and_b32 v147, s51, v182
    v_lshlrev_b32 v148, 16, v183
    v_and_b32 v149, s51, v183
    v_lshlrev_b32 v150, 16, v184
    v_and_b32 v151, s51, v184
    v_lshlrev_b32 v152, 16, v185
    v_and_b32 v153, s51, v185
    s_waitcnt lgkmcnt(2)
    v_lshlrev_b32 v154, 16, v186
    v_and_b32 v155, s51, v186
    v_lshlrev_b32 v156, 16, v187
    v_and_b32 v157, s51, v187
    v_lshlrev_b32 v158, 16, v188
    v_and_b32 v159, s51, v188
    v_lshlrev_b32 v160, 16, v189
    v_and_b32 v161, s51, v189
    v_pk_mul_f32 v[230:231], v[146:147], v[190:191]
    v_pk_mul_f32 v[232:233], v[148:149], v[192:193]
    v_pk_mul_f32 v[234:235], v[150:151], v[194:195]
    v_pk_mul_f32 v[236:237], v[152:153], v[196:197]
    v_pk_fma_f32 v[230:231], v[138:139], v[198:199], v[230:231]
    v_pk_fma_f32 v[232:233], v[140:141], v[200:201], v[232:233]
    v_pk_fma_f32 v[234:235], v[142:143], v[202:203], v[234:235]
    v_pk_fma_f32 v[236:237], v[144:145], v[204:205], v[236:237]
    v_pk_fma_f32 v[230:231], v[130:131], v[206:207], v[230:231]
    v_pk_fma_f32 v[232:233], v[132:133], v[208:209], v[232:233]
    v_pk_fma_f32 v[234:235], v[134:135], v[210:211], v[234:235]
    v_pk_fma_f32 v[236:237], v[136:137], v[212:213], v[236:237]
    v_pk_fma_f32 v[230:231], v[122:123], v[214:215], v[230:231]
    v_pk_fma_f32 v[232:233], v[124:125], v[216:217], v[232:233]
    v_pk_fma_f32 v[234:235], v[126:127], v[218:219], v[234:235]
    v_pk_fma_f32 v[236:237], v[128:129], v[220:221], v[236:237]
    v_pk_mul_f32 v[238:239], v[154:155], v[190:191]
    v_pk_mul_f32 v[240:241], v[156:157], v[192:193]
    v_pk_mul_f32 v[242:243], v[158:159], v[194:195]
    v_pk_mul_f32 v[244:245], v[160:161], v[196:197]
    v_pk_fma_f32 v[238:239], v[146:147], v[198:199], v[238:239]
    v_pk_fma_f32 v[240:241], v[148:149], v[200:201], v[240:241]
    v_pk_fma_f32 v[242:243], v[150:151], v[202:203], v[242:243]
    v_pk_fma_f32 v[244:245], v[152:153], v[204:205], v[244:245]
    v_pk_fma_f32 v[238:239], v[138:139], v[206:207], v[238:239]
    v_pk_fma_f32 v[240:241], v[140:141], v[208:209], v[240:241]
    v_pk_fma_f32 v[242:243], v[142:143], v[210:211], v[242:243]
    v_pk_fma_f32 v[244:245], v[144:145], v[212:213], v[244:245]
    v_pk_fma_f32 v[238:239], v[130:131], v[214:215], v[238:239]
    v_pk_fma_f32 v[240:241], v[132:133], v[216:217], v[240:241]
    v_pk_fma_f32 v[242:243], v[134:135], v[218:219], v[242:243]
    v_pk_fma_f32 v[244:245], v[136:137], v[220:221], v[244:245]
    s_waitcnt lgkmcnt(0)
    v_lshlrev_b32 v122, 16, v162
    v_and_b32 v123, s51, v162
    v_lshlrev_b32 v124, 16, v163
    v_and_b32 v125, s51, v163
    v_lshlrev_b32 v126, 16, v164
    v_and_b32 v127, s51, v164
    v_lshlrev_b32 v128, 16, v165
    v_and_b32 v129, s51, v165
    v_lshlrev_b32 v130, 16, v166
    v_and_b32 v131, s51, v166
    v_lshlrev_b32 v132, 16, v167
    v_and_b32 v133, s51, v167
    v_lshlrev_b32 v134, 16, v168
    v_and_b32 v135, s51, v168
    v_lshlrev_b32 v136, 16, v169
    v_and_b32 v137, s51, v169
    v_pk_mul_f32 v[230:231], v[230:231], v[122:123]
    v_pk_mul_f32 v[232:233], v[232:233], v[124:125]
    v_pk_mul_f32 v[234:235], v[234:235], v[126:127]
    v_pk_mul_f32 v[236:237], v[236:237], v[128:129]
    v_cvt_pk_bf16_f32 v162, v230, v231
    v_cvt_pk_bf16_f32 v163, v232, v233
    v_cvt_pk_bf16_f32 v164, v234, v235
    v_cvt_pk_bf16_f32 v165, v236, v237
    ds_write_b128 v50, v[162:165] offset:0
    v_pk_mul_f32 v[238:239], v[238:239], v[130:131]
    v_pk_mul_f32 v[240:241], v[240:241], v[132:133]
    v_pk_mul_f32 v[242:243], v[242:243], v[134:135]
    v_pk_mul_f32 v[244:245], v[244:245], v[136:137]
    v_cvt_pk_bf16_f32 v166, v238, v239
    v_cvt_pk_bf16_f32 v167, v240, v241
    v_cvt_pk_bf16_f32 v168, v242, v243
    v_cvt_pk_bf16_f32 v169, v244, v245
    ds_write_b128 v50, v[166:169] offset:64
    ds_read_b64_tr_b16 v[170:171], v51 offset:0
    ds_read_b64_tr_b16 v[172:173], v51 offset:256
    ds_read_b64_tr_b16 v[174:175], v52 offset:0
    ds_read_b64_tr_b16 v[176:177], v52 offset:256
    s_waitcnt lgkmcnt(2)
    buffer_store_dwordx4 v[170:173], v55, s[36:39], 0 offen
    s_waitcnt lgkmcnt(0)
    buffer_store_dwordx4 v[174:177], v56, s[36:39], 0 offen
    v_mov_b32 v4, 0
    global_load_dword v47, v4, s[46:47] sc1
    s_waitcnt vmcnt(5)
    s_barrier
    ds_read_b64_tr_b16 v[246:247], v66 offset:0
    ds_read_b64_tr_b16 v[248:249], v66 offset:1024
    ds_read_b64_tr_b16 v[250:251], v67 offset:0
    ds_read_b64_tr_b16 v[252:253], v67 offset:1024
    ds_read_b128 v[230:233], v40 offset:0
    ds_read_b128 v[234:237], v40 offset:16
    ds_read_b128 v[238:241], v40 offset:1024
    ds_read_b128 v[242:245], v40 offset:1040
    v_lshlrev_b32 v35, 7, v53
    v_lshl_add_u32 v35, v36, 3, v35
    v_lshrrev_b32 v34, 1, v44
    v_lshl_add_u32 v34, v54, 1, v34
    v_xor_b32 v34, s48, v34
    v_lshl_add_u32 v72, v34, 5, v35
    s_waitcnt lgkmcnt(6)
    buffer_store_dwordx4 v[246:249], v69, s[36:39], 0 offen sc1
    s_waitcnt lgkmcnt(4)
    buffer_store_dwordx4 v[250:253], v70, s[36:39], 0 offen sc1
    s_waitcnt vmcnt(2)
    v_readfirstlane_b32 s52, v47
    s_nop 0
    s_cmp_eq_u32 s52, 0
    s_cbranch_scc1 L_nslow_5
L_nok_4:
    s_mov_b64 exec, 1
    v_mov_b32 v4, 156928
    v_mov_b32 v5, 1
    ds_add_rtn_u32 v5, v4, v5
    s_lshl_b32 s54, s3, 7
    s_add_u32 s54, s54, 0
    v_mov_b32 v4, s52
    s_waitcnt lgkmcnt(0)
    v_readfirstlane_b32 s55, v5
    v_mov_b32 v5, s44
    s_cmp_lg_u32 s55, 3
    s_cbranch_scc1 L_sig_6
    buffer_store_dwordx2 v[4:5], v1, s[36:39], s54 offen
    s_add_u32 s54, s54, 262144
    buffer_store_dwordx2 v[4:5], v1, s[36:39], s54 offen sc1
L_sig_6:
    s_mov_b64 exec, -1
    s_lshl_b32 s55, s74, 1
    s_add_u32 m0, s55, 115968
    s_mov_b32 s54, 0
    buffer_load_dwordx4 v61, s[28:31], s54 offen lds
    s_add_u32 m0, s55, 116992
    s_mov_b32 s54, 49152
    buffer_load_dwordx4 v62, s[28:31], s54 offen lds
    s_add_u32 m0, s55, 118016
    s_mov_b32 s54, 98304
    buffer_load_dwordx4 v61, s[28:31], s54 offen lds
    s_add_u32 m0, s55, 119040
    s_mov_b32 s54, 147456
    buffer_load_dwordx4 v62, s[28:31], s54 offen lds
    s_mov_b32 s56, 0x3f803f80
    v_dot2_f32_bf16 v48, v222, s56, 0
    v_dot2_f32_bf16 v49, v222, v222, 0
    v_dot2_f32_bf16 v48, v223, s56, v48
    v_dot2_f32_bf16 v49, v223, v223, v49
    v_dot2_f32_bf16 v48, v224, s56, v48
    v_dot2_f32_bf16 v49, v224, v224, v49
    v_dot2_f32_bf16 v48, v225, s56, v48
    v_dot2_f32_bf16 v49, v225, v225, v49
    v_dot2_f32_bf16 v48, v226, s56, v48
    v_dot2_f32_bf16 v49, v226, v226, v49
    v_dot2_f32_bf16 v48, v227, s56, v48
    v_dot2_f32_bf16 v49, v227, v227, v49
    v_dot2_f32_bf16 v48, v228, s56, v48
    v_dot2_f32_bf16 v49, v228, v228, v49
    v_dot2_f32_bf16 v48, v229, s56, v48
    v_dot2_f32_bf16 v49, v229, v229, v49
    s_nop 1
    v_add_f32_dpp v48, v48, v48 row_ror:8 row_mask:0xf bank_mask:0xf
    v_add_f32_dpp v49, v49, v49 row_ror:8 row_mask:0xf bank_mask:0xf
    v_add_u32 v50, 99328, v72
    v_add_f32_dpp v48, v48, v48 row_ror:4 row_mask:0xf bank_mask:0xf
    v_add_f32_dpp v49, v49, v49 row_ror:4 row_mask:0xf bank_mask:0xf
    v_add_u32 v51, 115968, v72
    v_add_f32_dpp v48, v48, v48 row_ror:2 row_mask:0xf bank_mask:0xf
    v_add_f32_dpp v49, v49, v49 row_ror:2 row_mask:0xf bank_mask:0xf
    s_nop 0
    v_add_f32_dpp v48, v48, v48 row_ror:1 row_mask:0xf bank_mask:0xf
    v_add_f32_dpp v49, v49, v49 row_ror:1 row_mask:0xf bank_mask:0xf
    s_nop 0
    v_add_f32_dpp v48, v48, v48 row_bcast:15 row_mask:0xa bank_mask:0xf
    v_add_f32_dpp v49, v49, v49 row_bcast:15 row_mask:0xa bank_mask:0xf
    v_mul_f32 v48, 0x3b000000, v48
    v_mul_f32 v49, 0x3b000000, v49
    v_fma_f32 v49, -v48, v48, v49
    v_max_f32 v49, 0, v49
    v_add_f32 v49, 0x3727c5ac, v49
    v_rsq_f32 v49, v49
    s_mov_b32 exec_lo, 0x10000
    v_mul_f32_e64 v48, -v48, v49
    s_mov_b32 exec_hi, 0x10000
    s_nop 0
    buffer_store_dword v49, v45, s[36:39], 0 offen sc1
    buffer_store_dword v48, v46, s[36:39], 0 offen sc1
    s_mov_b64 exec, -1
    s_add_u32 m0, s74, 99328
    s_movk_i32 s54, 0x2000
    buffer_load_dwordx4 v59, s[12:15], 0 offen lds
    s_add_u32 m0, s74, 100352
    s_lshl_b32 s55, s74, 1
    buffer_load_dwordx4 v60, s[12:15], s54 offen lds
    s_add_u32 m0, s74, 140544
    s_movk_i32 s54, 0x1000
    buffer_load_dwordx4 v58, s[24:27], 0 offen lds
    s_add_u32 m0, s74, 141568
    s_nop 0
    buffer_load_dwordx4 v58, s[24:27], s54 offen lds
    v_lshlrev_b32 v122, 16, v41
    v_and_b32 v123, s51, v41
    v_mul_f32 v124, 0xbfb8aa3b, v122
    v_mul_f32 v125, 0xbfb8aa3b, v123
    v_exp_f32 v124, v124
    v_exp_f32 v125, v125
    v_add_f32 v124, 1.0, v124
    v_add_f32 v125, 1.0, v125
    v_rcp_f32 v124, v124
    v_rcp_f32 v125, v125
    v_lshlrev_b32 v127, 2, v0
    v_mul_f32 v122, v122, v124
    v_mul_f32 v123, v123, v125
    v_add_u32 v127, 76800, v127
    v_cvt_pk_bf16_f32 v126, v122, v123
    ds_write_b32 v127, v126
    v_bfi_b32 v190, s51, v236, v237
    v_bfi_b32 v191, s51, v235, v236
    v_bfi_b32 v192, s51, v234, v235
    v_bfi_b32 v193, s51, v233, v234
    v_bfi_b32 v194, s51, v232, v233
    v_bfi_b32 v195, s51, v231, v232
    ds_write_b128 v39, v[190:193] offset:24960
    v_and_b32 v22, 31, v1
    v_lshlrev_b32 v22, 7, v22
    s_lshl_b32 s83, s49, 12
    s_and_b32 s73, s50, 7
    s_lshr_b32 s67, s50, 3
    s_lshl_b32 s72, s49, 2
    s_add_u32 s72, s72, s67
    s_lshl_b32 s66, s70, 12
    ds_write_b128 v39, v[192:195] offset:8320
    s_add_u32 s82, s66, 1048576
    s_lshl_b32 s67, s71, 10
    s_add_u32 s66, s66, s67
    s_add_u32 s41, s66, 3145728
    s_add_u32 s42, s66, 5242880
    s_lshl_b32 s81, s48, 12
    s_add_u32 s43, s81, 98304
    s_add_u32 s76, s81, 98304
    v_bfi_b32 v200, s51, v235, v236
    v_bfi_b32 v201, s51, v234, v235
    v_bfi_b32 v202, s51, v233, v234
    v_bfi_b32 v203, s51, v232, v233
    v_bfi_b32 v204, s51, v231, v232
    v_bfi_b32 v205, s51, v230, v231
    ds_write_b128 v39, v[200:203] offset:16640
    s_lshl_b32 s77, s70, 2
    s_add_u32 s77, s77, 131072
    s_cmp_lt_u32 s48, 2
    s_cselect_b32 s78, 2048, 0
    s_add_u32 s78, s78, 137216
    s_lshl_b32 s79, s73, 8
    s_add_u32 s79, s79, 141312
    s_lshl_b32 s80, s48, 17
    ds_write_b128 v39, v[202:205] offset:0
    s_lshl_b32 s67, s72, 7
    s_add_u32 s80, s80, s67
    s_add_u32 s80, s80, 5242880
    s_lshl_b32 s40, s73, 2
    s_add_u32 s40, s40, s48
    s_mul_i32 s4, s40, 34816
    s_lshl_b32 s40, s40, 10
    s_add_u32 s4, s4, 7340032
    v_alignbit_b32 v206, v237, v237, 16
    v_alignbit_b32 v207, v236, v236, 16
    v_alignbit_b32 v208, v235, v235, 16
    v_alignbit_b32 v209, v234, v234, 16
    v_alignbit_b32 v210, v233, v233, 16
    v_alignbit_b32 v211, v232, v232, 16
    ds_write_b128 v39, v[206:209] offset:29120
    s_add_u32 s5, s4, 17408
    s_mul_i32 s66, s73, 3
    s_add_u32 s66, s66, s48
    s_cmp_lt_u32 s66, 22
    s_cselect_b32 s67, s48, 3
    s_mul_i32 s66, s66, 17408
    s_add_u32 s66, s66, 8454144
    s_cmp_lt_u32 s67, 3
    s_cselect_b32 s6, s66, 0x7f000000
    ds_write_b128 v39, v[208:211] offset:12480
    s_add_u32 s59, s48, 0
    s_and_b32 s59, s59, 3
    s_mul_i32 s7, s73, 43
    s_mul_i32 s67, s59, 11
    s_add_u32 s7, s7, s67
    s_lshl_b32 s7, s7, 12
    s_add_u32 s7, s7, 8912896
    s_lshl_b32 s67, s71, 11
    v_alignbit_b32 v216, v236, v236, 16
    v_alignbit_b32 v217, v235, v235, 16
    v_alignbit_b32 v218, v234, v234, 16
    v_alignbit_b32 v219, v233, v233, 16
    v_alignbit_b32 v220, v232, v232, 16
    v_alignbit_b32 v221, v231, v231, 16
    ds_write_b128 v39, v[216:219] offset:20800
    s_add_u32 s7, s7, s67
    s_xor_b32 s12, s7, 0x800
    s_lshl_b32 s67, s72, 2
    s_xor_b32 s66, s71, 0
    s_lshl_b32 s16, s66, 7
    s_add_u32 s66, s66, s67
    s_mul_i32 s8, s66, 44032
    s_add_u32 s8, s8, 10485760
    ds_write_b128 v39, v[218:221] offset:4160
    s_xor_b32 s66, s71, 1
    s_lshl_b32 s17, s66, 7
    s_add_u32 s66, s66, s67
    s_mul_i32 s9, s66, 44032
    s_add_u32 s9, s9, 10485760
    s_xor_b32 s66, s71, 2
    s_lshl_b32 s18, s66, 7
    s_add_u32 s66, s66, s67
    v_bfi_b32 v130, s51, v244, v245
    v_bfi_b32 v131, s51, v243, v244
    v_bfi_b32 v132, s51, v242, v243
    v_bfi_b32 v133, s51, v241, v242
    v_bfi_b32 v134, s51, v240, v241
    v_bfi_b32 v135, s51, v239, v240
    ds_write_b128 v39, v[130:133] offset:25984
    s_mul_i32 s10, s66, 44032
    s_add_u32 s10, s10, 10485760
    s_xor_b32 s66, s71, 3
    s_lshl_b32 s19, s66, 7
    s_add_u32 s66, s66, s67
    s_mul_i32 s11, s66, 44032
    s_add_u32 s11, s11, 10485760
    s_lshl_b32 s66, s53, 16
    ds_write_b128 v39, v[132:135] offset:9344
    s_and_b32 s67, s53, s51
    s_cmp_lt_u32 s48, 2
    s_cselect_b32 s68, s66, s67
    s_mov_b32 s53, s59
    v_lshrrev_b32 v34, 2, v2
    v_cmp_eq_u32 s[62:63], v34, v3
    v_and_b32 v37, 1, v2
    v_lshlrev_b32 v37, 4, v37
    v_bfi_b32 v140, s51, v243, v244
    v_bfi_b32 v141, s51, v242, v243
    v_bfi_b32 v142, s51, v241, v242
    v_bfi_b32 v143, s51, v240, v241
    v_bfi_b32 v144, s51, v239, v240
    v_bfi_b32 v145, s51, v238, v239
    ds_write_b128 v39, v[140:143] offset:17664
    s_mov_b32 s66, 0xffff
    v_lshlrev_b32_e64 v37, v37, s66
    v_and_b32 v38, 2, v2
    v_cmp_eq_u32 vcc, 0, v38
    v_cndmask_b32 v37, 0, v37, s[62:63]
    v_lshlrev_b32 v9, 4, v3
    v_cndmask_b32 v7, 0, v37, vcc
    v_cndmask_b32 v8, v37, 0, vcc
    ds_write_b128 v39, v[142:145] offset:1024
    v_cmp_eq_u32 vcc, 1, v2
    v_add_u32 v9, 77824, v9
    v_add_u32 v37, 1024, v9
    v_cndmask_b32 v10, v9, v37, vcc
    s_mul_i32 s57, s75, 33280
    s_mul_i32 s56, s75, 5120
    s_add_u32 s56, s56, 66560
    v_mul_u32_u24 v16, 12288, v36
    v_alignbit_b32 v146, v245, v245, 16
    v_alignbit_b32 v147, v244, v244, 16
    v_alignbit_b32 v148, v243, v243, 16
    v_alignbit_b32 v149, v242, v242, 16
    v_alignbit_b32 v150, v241, v241, 16
    v_alignbit_b32 v151, v240, v240, 16
    ds_write_b128 v39, v[146:149] offset:30144
    v_mul_u32_u24 v11, 4160, v36
    v_mul_u32_u24 v37, 1280, v36
    v_and_b32 v38, 60, v1
    v_lshl_add_u32 v37, v38, 2, v37
    s_lshl_b32 s66, s71, 9
    s_add_u32 s66, s66, s56
    v_add_u32 v14, s66, v37
    v_lshl_add_u32 v16, v34, 11, v16
    ds_write_b128 v39, v[148:151] offset:13504
    v_sub_u32 v38, v34, v3
    v_lshl_add_u32 v11, v38, 4, v11
    s_lshl_b32 s66, s71, 6
    s_add_u32 s66, s66, s57
    s_add_u32 s66, s66, 48
    v_add_u32 v11, s66, v11
    v_lshlrev_b32 v18, 4, v2
    v_mul_u32_u24 v13, 1280, v3
    buffer_load_dwordx2 v[72:73], v22, s[36:39], s83 offen sc1
    v_alignbit_b32 v156, v244, v244, 16
    v_alignbit_b32 v157, v243, v243, 16
    v_alignbit_b32 v158, v242, v242, 16
    v_alignbit_b32 v159, v241, v241, 16
    v_alignbit_b32 v160, v240, v240, 16
    v_alignbit_b32 v161, v239, v239, 16
    ds_write_b128 v39, v[156:159] offset:21824
    v_add3_u32 v13, v13, v18, s56
    s_lshl_b32 s66, s71, 4
    v_subrev_u32 v12, s66, v13
    s_lshl_b32 s66, s71, 8
    v_add_u32 v13, s66, v13
    s_add_u32 s66, s66, 98304
    v_lshl_add_u32 v19, v3, 11, v18
    v_add_u32 v19, s66, v19
    ds_write_b128 v39, v[158:161] offset:5184
    v_lshlrev_b32 v15, 6, v2
    v_lshl_add_u32 v15, v3, 4, v15
    v_and_b32 v17, 127, v0
    v_lshlrev_b32 v17, 4, v17
    s_add_u32 s66, s81, 81920
    v_add_u32 v20, s66, v6
    v_mul_u32_u24 v21, 12288, v3
    v_add_u32 v21, v21, v18
    v_mov_b32 v28, s52
    v_mov_b32 v29, s44
    v_cmp_eq_u32 vcc, 0, v1
    v_lshlrev_b32 v37, 2, v1
    v_add_u32 v37, 156960, v37
    v_mov_b32 v38, 156928
    v_cndmask_b32 v24, v37, v38, vcc
    v_mov_b32 v37, 0x7f000000
    v_cndmask_b32 v27, v37, 0, vcc
    v_mov_b32 v26, 1
    s_waitcnt vmcnt(1)
    s_waitcnt vmcnt(0)
    buffer_load_dwordx4 v[238:241], v23, s[36:39], s82 offen sc1
    buffer_load_dwordx4 v[242:245], v23, s[36:39], s82 offen offset:1024 sc1
    s_mov_b64 exec, 1
    v_mov_b32 v4, 156944
    v_mov_b32 v5, 1
    ds_add_rtn_u32 v5, v4, v5
    s_lshl_b32 s54, s3, 2
    s_add_u32 s54, s54, 49152
    v_mov_b32 v4, s52
    s_waitcnt lgkmcnt(0)
    v_readfirstlane_b32 s55, v5
    v_mov_b32 v5, s44
    s_cmp_lg_u32 s55, 3
    s_cbranch_scc1 L_sig_7
    buffer_store_dword v4, v1, s[36:39], s54 offen sc1
L_sig_7:
    s_mov_b64 exec, -1
    s_barrier
    ds_read_b64_tr_b16 v[198:199], v50 offset:0
    ds_read_b64_tr_b16 v[200:201], v50 offset:512
    ds_read_b64_tr_b16 v[202:203], v50 offset:4096
    ds_read_b64_tr_b16 v[204:205], v50 offset:4608
    ds_read_b128 v[222:225], v65 offset:0
    ds_read_b64_tr_b16 v[206:207], v51 offset:0
    ds_read_b64_tr_b16 v[208:209], v51 offset:512
    ds_read_b128 v[226:229], v65 offset:64
    ds_read_b64_tr_b16 v[210:211], v51 offset:4096
    ds_read_b64_tr_b16 v[212:213], v51 offset:4608
    ds_read_b128 v[230:233], v65 offset:128
    ds_read_b64_tr_b16 v[214:215], v51 offset:8192
    ds_read_b64_tr_b16 v[216:217], v51 offset:8704
    ds_read_b128 v[234:237], v65 offset:192
    ds_read_b64_tr_b16 v[218:219], v51 offset:12288
    ds_read_b64_tr_b16 v[220:221], v51 offset:12800
    s_waitcnt lgkmcnt(14)
    buffer_store_dwordx4 v[198:201], v57, s[36:39], 0 offen offset:0
    s_waitcnt lgkmcnt(12)
    buffer_store_dwordx4 v[202:205], v57, s[36:39], 0 offen offset:64
    ds_read_b64_tr_b16 v[246:247], v68 offset:0
    ds_read_b64_tr_b16 v[248:249], v68 offset:1024
    ds_read_b64_tr_b16 v[250:251], v68 offset:8
    ds_read_b64_tr_b16 v[252:253], v68 offset:1032
    s_waitcnt lgkmcnt(13)
    v_mfma_f32_16x16x32_bf16 v[30:33], v[206:209], v[222:225], 0
    s_waitcnt lgkmcnt(10)
    v_mfma_f32_16x16x32_bf16 v[30:33], v[210:213], v[226:229], v[30:33]
    s_waitcnt lgkmcnt(7)
    v_mfma_f32_16x16x32_bf16 v[30:33], v[214:217], v[230:233], v[30:33]
    s_waitcnt lgkmcnt(4)
    v_mfma_f32_16x16x32_bf16 v[30:33], v[218:221], v[234:237], v[30:33]
    s_waitcnt lgkmcnt(0)
    s_mov_b32 exec_lo, 0x00010001
    s_mov_b32 exec_hi, 0x00010001
    s_nop 4
    buffer_store_dwordx4 v[30:33], v63, s[36:39], 0 offen
    s_mov_b64 exec, -1
    s_mov_b32 s61, 0
    v_xor_b32 v72, s52, v72
    v_xor_b32 v73, s44, v73
    v_or_b32 v72, v72, v73
    v_cmp_ne_u32 vcc, 0, v72
    s_cbranch_vccnz L_p1c_10
L_p1d_9:
    buffer_store_dwordx4 v[246:249], v71, s[36:39], 0 offen offset:0 sc1
    buffer_store_dwordx4 v[250:253], v71, s[36:39], 0 offen offset:1024 sc1
    s_mov_b32 exec_lo, 0x00010001
    s_mov_b32 exec_hi, 0x00010001
    buffer_store_dwordx4 v[30:33], v64, s[36:39], 0 offen sc1
    s_mov_b64 exec, -1
    ds_read_b128 v[158:161], v11 offset:0
    ds_read_b128 v[162:165], v11 offset:16640
    ds_read_b128 v[166:169], v11 offset:128
    ds_read_b128 v[170:173], v11 offset:16768
    ds_read_b128 v[174:177], v11 offset:256
    ds_read_b128 v[178:181], v11 offset:16896
    s_waitcnt vmcnt(6)
    ds_write_b128 v14, v[238:241] offset:256
    ds_write_b128 v14, v[242:245] offset:512
    s_waitcnt lgkmcnt(0)
    s_barrier
    ds_read_b128 v[118:121], v12 offset:1024
    ds_read_b128 v[126:129], v12 offset:768
    ds_read_b128 a[224:227], v12 offset:512
    ds_read_b128 a[192:195], v12 offset:256
    ds_read_b128 v[122:125], v12 offset:992
    ds_read_b128 v[130:133], v12 offset:736
    ds_read_b128 a[228:231], v12 offset:480
    ds_read_b128 a[196:199], v12 offset:224
    s_waitcnt lgkmcnt(4)
    v_mfma_f32_16x16x32_bf16 v[230:233], v[158:161], v[118:121], 0
    s_waitcnt vmcnt(3)
    ds_add_rtn_u32 v25, v24, v26 offset:4
    v_mfma_f32_16x16x32_bf16 v[234:237], v[162:165], v[118:121], 0
    s_lshl_b32 s54, s3, 7
    s_add_u32 s54, s54, 294912
    v_mfma_f32_16x16x32_bf16 v[222:225], v[158:161], v[126:129], 0
    v_mfma_f32_16x16x32_bf16 v[226:229], v[162:165], v[126:129], 0
    s_waitcnt lgkmcnt(0)
    v_mfma_f32_16x16x32_bf16 v[214:217], v[158:161], a[224:227], 0
    v_readfirstlane_b32 s55, v25
    v_mfma_f32_16x16x32_bf16 v[218:221], v[162:165], a[224:227], 0
    s_cmp_lg_u32 s55, 3
    s_cbranch_scc1 L_sig_11
    buffer_store_dwordx2 v[28:29], v27, s[36:39], s54 offen
L_sig_11:
    v_mfma_f32_16x16x32_bf16 v[206:209], v[158:161], a[192:195], 0
    v_mfma_f32_16x16x32_bf16 v[210:213], v[162:165], a[192:195], 0
    ds_read_b128 v[118:121], v12 offset:960
    v_mfma_f32_16x16x32_bf16 v[230:233], v[166:169], v[122:125], v[230:233]
    ds_read_b128 v[134:137], v12 offset:704
    v_mfma_f32_16x16x32_bf16 v[234:237], v[170:173], v[122:125], v[234:237]
    ds_read_b128 a[232:235], v12 offset:448
    v_mfma_f32_16x16x32_bf16 v[222:225], v[166:169], v[130:133], v[222:225]
    ds_read_b128 a[200:203], v12 offset:192
    v_mfma_f32_16x16x32_bf16 v[226:229], v[170:173], v[130:133], v[226:229]
    ds_read_b128 v[182:185], v11 offset:384
    v_mfma_f32_16x16x32_bf16 v[214:217], v[166:169], a[228:231], v[214:217]
    ds_read_b128 v[186:189], v11 offset:17024
    v_mfma_f32_16x16x32_bf16 v[218:221], v[170:173], a[228:231], v[218:221]
    v_mfma_f32_16x16x32_bf16 v[206:209], v[166:169], a[196:199], v[206:209]
    v_mfma_f32_16x16x32_bf16 v[210:213], v[170:173], a[196:199], v[210:213]
    ds_read_b128 v[122:125], v12 offset:928
    s_waitcnt lgkmcnt(3)
    v_mfma_f32_16x16x32_bf16 v[230:233], v[174:177], v[118:121], v[230:233]
    ds_read_b128 v[138:141], v12 offset:672
    v_mfma_f32_16x16x32_bf16 v[234:237], v[178:181], v[118:121], v[234:237]
    ds_read_b128 a[236:239], v12 offset:416
    v_mfma_f32_16x16x32_bf16 v[222:225], v[174:177], v[134:137], v[222:225]
    ds_read_b128 a[204:207], v12 offset:160
    v_mfma_f32_16x16x32_bf16 v[226:229], v[178:181], v[134:137], v[226:229]
    ds_read_b128 v[190:193], v11 offset:512
    v_mfma_f32_16x16x32_bf16 v[214:217], v[174:177], a[232:235], v[214:217]
    ds_read_b128 v[194:197], v11 offset:17152
    v_mfma_f32_16x16x32_bf16 v[218:221], v[178:181], a[232:235], v[218:221]
    v_mfma_f32_16x16x32_bf16 v[206:209], v[174:177], a[200:203], v[206:209]
    v_mfma_f32_16x16x32_bf16 v[210:213], v[178:181], a[200:203], v[210:213]
    ds_read_b128 v[118:121], v12 offset:896
    s_waitcnt lgkmcnt(3)
    v_mfma_f32_16x16x32_bf16 v[230:233], v[182:185], v[122:125], v[230:233]
    ds_read_b128 v[142:145], v12 offset:640
    s_waitcnt vmcnt(0)
    v_mfma_f32_16x16x32_bf16 v[234:237], v[186:189], v[122:125], v[234:237]
    ds_read_b128 a[240:243], v12 offset:384
    ds_add_rtn_u32 v25, v24, v26 offset:20
    v_mfma_f32_16x16x32_bf16 v[222:225], v[182:185], v[138:141], v[222:225]
    ds_read_b128 a[208:211], v12 offset:128
    s_lshl_b32 s54, s3, 2
    v_mfma_f32_16x16x32_bf16 v[226:229], v[186:189], v[138:141], v[226:229]
    ds_read_b128 v[198:201], v11 offset:640
    s_add_u32 s54, s54, 32768
    v_mfma_f32_16x16x32_bf16 v[214:217], v[182:185], a[236:239], v[214:217]
    ds_read_b128 v[202:205], v11 offset:17280
    v_mfma_f32_16x16x32_bf16 v[218:221], v[186:189], a[236:239], v[218:221]
    v_mfma_f32_16x16x32_bf16 v[206:209], v[182:185], a[204:207], v[206:209]
    s_waitcnt lgkmcnt(3)
    v_readfirstlane_b32 s55, v25
    v_mfma_f32_16x16x32_bf16 v[210:213], v[186:189], a[204:207], v[210:213]
    ds_read_b128 v[122:125], v12 offset:864
    s_waitcnt lgkmcnt(3)
    v_mfma_f32_16x16x32_bf16 v[230:233], v[190:193], v[118:121], v[230:233]
    ds_read_b128 v[146:149], v12 offset:608
    s_cmp_lg_u32 s55, 3
    s_cbranch_scc1 L_sig_12
    buffer_store_dword v28, v27, s[36:39], s54 offen sc1
L_sig_12:
    v_mfma_f32_16x16x32_bf16 v[234:237], v[194:197], v[118:121], v[234:237]
    ds_read_b128 a[244:247], v12 offset:352
    v_mfma_f32_16x16x32_bf16 v[222:225], v[190:193], v[142:145], v[222:225]
    ds_read_b128 a[212:215], v12 offset:96
    v_mfma_f32_16x16x32_bf16 v[226:229], v[194:197], v[142:145], v[226:229]
    ds_read_b128 v[158:161], v11 offset:768
    v_mfma_f32_16x16x32_bf16 v[214:217], v[190:193], a[240:243], v[214:217]
    ds_read_b128 v[162:165], v11 offset:17408
    v_mfma_f32_16x16x32_bf16 v[218:221], v[194:197], a[240:243], v[218:221]
    v_mfma_f32_16x16x32_bf16 v[206:209], v[190:193], a[208:211], v[206:209]
    v_mfma_f32_16x16x32_bf16 v[210:213], v[194:197], a[208:211], v[210:213]
    ds_read_b128 v[118:121], v12 offset:832
    s_mov_b32 s56, 49152
    buffer_load_dwordx4 v[40:43], v6, s[36:39], s56 offen sc1
    s_waitcnt lgkmcnt(3)
    v_mfma_f32_16x16x32_bf16 v[230:233], v[198:201], v[122:125], v[230:233]
    ds_read_b128 v[150:153], v12 offset:576
    v_mfma_f32_16x16x32_bf16 v[234:237], v[202:205], v[122:125], v[234:237]
    ds_read_b128 a[248:251], v12 offset:320
    v_mfma_f32_16x16x32_bf16 v[222:225], v[198:201], v[146:149], v[222:225]
    ds_read_b128 a[216:219], v12 offset:64
    v_mfma_f32_16x16x32_bf16 v[226:229], v[202:205], v[146:149], v[226:229]
    ds_read_b128 v[166:169], v11 offset:896
    v_mfma_f32_16x16x32_bf16 v[214:217], v[198:201], a[244:247], v[214:217]
    ds_read_b128 v[170:173], v11 offset:17536
    v_mfma_f32_16x16x32_bf16 v[218:221], v[202:205], a[244:247], v[218:221]
    v_mfma_f32_16x16x32_bf16 v[206:209], v[198:201], a[212:215], v[206:209]
    v_mfma_f32_16x16x32_bf16 v[210:213], v[202:205], a[212:215], v[210:213]
    ds_read_b128 v[122:125], v12 offset:800
    s_waitcnt lgkmcnt(3)
    v_mfma_f32_16x16x32_bf16 v[230:233], v[158:161], v[118:121], v[230:233]
    ds_read_b128 v[154:157], v12 offset:544
    v_mfma_f32_16x16x32_bf16 v[234:237], v[162:165], v[118:121], v[234:237]
    ds_read_b128 a[252:255], v12 offset:288
    v_mfma_f32_16x16x32_bf16 v[222:225], v[158:161], v[150:153], v[222:225]
    ds_read_b128 a[220:223], v12 offset:32
    v_mfma_f32_16x16x32_bf16 v[226:229], v[162:165], v[150:153], v[226:229]
    ds_read_b128 v[174:177], v11 offset:1024
    v_mfma_f32_16x16x32_bf16 v[214:217], v[158:161], a[248:251], v[214:217]
    ds_read_b128 v[178:181], v11 offset:17664
    v_mfma_f32_16x16x32_bf16 v[218:221], v[162:165], a[248:251], v[218:221]
    ds_read_b128 v[182:185], v11 offset:1152
    v_mfma_f32_16x16x32_bf16 v[206:209], v[158:161], a[216:219], v[206:209]
    ds_read_b128 v[186:189], v11 offset:17792
    v_mfma_f32_16x16x32_bf16 v[210:213], v[162:165], a[216:219], v[210:213]
    ds_read_b128 v[190:193], v11 offset:1280
    s_add_u32 s56, s83, 294912
    buffer_load_dwordx2 v[44:45], v22, s[36:39], s56 offen sc1
    s_waitcnt lgkmcnt(5)
    v_mfma_f32_16x16x32_bf16 v[230:233], v[166:169], v[122:125], v[230:233]
    ds_read_b128 v[194:197], v11 offset:17920
    v_mfma_f32_16x16x32_bf16 v[234:237], v[170:173], v[122:125], v[234:237]
    ds_read_b128 v[198:201], v11 offset:1408
    v_mfma_f32_16x16x32_bf16 v[222:225], v[166:169], v[154:157], v[222:225]
    ds_read_b128 v[202:205], v11 offset:18048
    v_mfma_f32_16x16x32_bf16 v[226:229], v[170:173], v[154:157], v[226:229]
    ds_read_b128 v[158:161], v11 offset:1536
    v_mfma_f32_16x16x32_bf16 v[214:217], v[166:169], a[252:255], v[214:217]
    ds_read_b128 v[162:165], v11 offset:18176
    v_mfma_f32_16x16x32_bf16 v[218:221], v[170:173], a[252:255], v[218:221]
    v_mfma_f32_16x16x32_bf16 v[206:209], v[166:169], a[220:223], v[206:209]
    v_mfma_f32_16x16x32_bf16 v[210:213], v[170:173], a[220:223], v[210:213]
    ds_read_b128 v[166:169], v11 offset:1664
    s_waitcnt lgkmcnt(9)
    v_mfma_f32_16x16x32_bf16 v[230:233], v[174:177], v[126:129], v[230:233]
    ds_read_b128 v[170:173], v11 offset:18304
    v_mfma_f32_16x16x32_bf16 v[234:237], v[178:181], v[126:129], v[234:237]
    v_mfma_f32_16x16x32_bf16 v[222:225], v[174:177], a[224:227], v[222:225]
    v_mfma_f32_16x16x32_bf16 v[226:229], v[178:181], a[224:227], v[226:229]
    v_mfma_f32_16x16x32_bf16 v[214:217], v[174:177], a[192:195], v[214:217]
    v_mfma_f32_16x16x32_bf16 v[218:221], v[178:181], a[192:195], v[218:221]
    ds_read_b128 v[174:177], v11 offset:1792
    s_waitcnt lgkmcnt(9)
    v_mfma_f32_16x16x32_bf16 v[230:233], v[182:185], v[130:133], v[230:233]
    ds_read_b128 v[178:181], v11 offset:18432
    v_mfma_f32_16x16x32_bf16 v[234:237], v[186:189], v[130:133], v[234:237]
    v_mfma_f32_16x16x32_bf16 v[222:225], v[182:185], a[228:231], v[222:225]
    v_mfma_f32_16x16x32_bf16 v[226:229], v[186:189], a[228:231], v[226:229]
    v_mfma_f32_16x16x32_bf16 v[214:217], v[182:185], a[196:199], v[214:217]
    v_mfma_f32_16x16x32_bf16 v[218:221], v[186:189], a[196:199], v[218:221]
    ds_read_b128 v[182:185], v11 offset:1920
    s_waitcnt lgkmcnt(9)
    v_mfma_f32_16x16x32_bf16 v[230:233], v[190:193], v[134:137], v[230:233]
    ds_read_b128 v[186:189], v11 offset:18560
    s_waitcnt vmcnt(1)
    v_mfma_f32_16x16x32_bf16 v[234:237], v[194:197], v[134:137], v[234:237]
    v_xor_b32 v40, s52, v40
    v_xor_b32 v41, s52, v41
    v_mfma_f32_16x16x32_bf16 v[222:225], v[190:193], a[232:235], v[222:225]
    v_xor_b32 v42, s52, v42
    v_xor_b32 v43, s52, v43
    v_mfma_f32_16x16x32_bf16 v[226:229], v[194:197], a[232:235], v[226:229]
    v_or3_b32 v40, v40, v41, v42
    v_or_b32 v40, v40, v43
    v_mfma_f32_16x16x32_bf16 v[214:217], v[190:193], a[200:203], v[214:217]
    v_cmp_ne_u32 vcc, 0, v40
    s_cbranch_vccnz L_slow_13
L_back_14:
    s_mov_b32 m0, s76
    s_nop 0
    buffer_load_dwordx4 v6, s[36:39], s43 offen offset:0 sc1 lds
    v_mfma_f32_16x16x32_bf16 v[218:221], v[194:197], a[200:203], v[218:221]
    ds_read_b128 v[190:193], v11 offset:2048
    s_waitcnt vmcnt(1)
    s_cmp_eq_u32 s71, 0
    s_cbranch_scc1 L_send_17
    ds_write_b128 v20, v[206:209] offset:0
    ds_write_b128 v20, v[210:213] offset:1024
L_send_17:
    s_waitcnt lgkmcnt(9)
    v_mfma_f32_16x16x32_bf16 v[230:233], v[198:201], v[138:141], v[230:233]
    ds_read_b128 v[194:197], v11 offset:18688
    v_xor_b32 v44, s52, v44
    v_mfma_f32_16x16x32_bf16 v[234:237], v[202:205], v[138:141], v[234:237]
    v_xor_b32 v45, s44, v45
    v_or_b32 v44, v44, v45
    buffer_load_dwordx4 v6, s[36:39], s43 offen offset:1024 sc1 lds
    v_mfma_f32_16x16x32_bf16 v[222:225], v[198:201], a[236:239], v[222:225]
    v_cmp_ne_u32 vcc, 0, v44
    s_cbranch_vccnz L_slow_15
L_back_16:
    v_mfma_f32_16x16x32_bf16 v[226:229], v[202:205], a[236:239], v[226:229]
    v_mfma_f32_16x16x32_bf16 v[214:217], v[198:201], a[204:207], v[214:217]
    buffer_load_dwordx4 v6, s[36:39], s43 offen offset:2048 sc1 lds
    v_mfma_f32_16x16x32_bf16 v[218:221], v[202:205], a[204:207], v[218:221]
    ds_read_b128 v[198:201], v11 offset:2176
    s_waitcnt lgkmcnt(9)
    v_mfma_f32_16x16x32_bf16 v[230:233], v[158:161], v[142:145], v[230:233]
    ds_read_b128 v[202:205], v11 offset:18816
    ds_read_b128 v[118:121], v13 offset:256
    v_mfma_f32_16x16x32_bf16 v[234:237], v[162:165], v[142:145], v[234:237]
    ds_read_b128 v[122:125], v13 offset:768
    buffer_load_dwordx4 v6, s[36:39], s43 offen offset:3072 sc1 lds
    v_mfma_f32_16x16x32_bf16 v[222:225], v[158:161], a[240:243], v[222:225]
    v_mfma_f32_16x16x32_bf16 v[226:229], v[162:165], a[240:243], v[226:229]
    v_mfma_f32_16x16x32_bf16 v[214:217], v[158:161], a[208:211], v[214:217]
    buffer_load_dwordx4 v[248:251], v15, s[36:39], s41 offen sc1
    v_mfma_f32_16x16x32_bf16 v[218:221], v[162:165], a[208:211], v[218:221]
    ds_read_b128 v[158:161], v11 offset:2304
    s_waitcnt lgkmcnt(11)
    v_mfma_f32_16x16x32_bf16 v[230:233], v[166:169], v[146:149], v[230:233]
    ds_read_b128 v[162:165], v11 offset:18944
    v_mfma_f32_16x16x32_bf16 v[234:237], v[170:173], v[146:149], v[234:237]
    buffer_load_dwordx4 v[252:255], v15, s[36:39], s41 offen offset:2048 sc1
    v_mfma_f32_16x16x32_bf16 v[222:225], v[166:169], a[244:247], v[222:225]
    v_mfma_f32_16x16x32_bf16 v[226:229], v[170:173], a[244:247], v[226:229]
    v_mfma_f32_16x16x32_bf16 v[214:217], v[166:169], a[212:215], v[214:217]
    buffer_load_dword v14, v16, s[36:39], s77 offen sc1
    v_mfma_f32_16x16x32_bf16 v[218:221], v[170:173], a[212:215], v[218:221]
    ds_read_b128 v[166:169], v11 offset:2432
    s_waitcnt lgkmcnt(11)
    v_mfma_f32_16x16x32_bf16 v[230:233], v[174:177], v[150:153], v[230:233]
    ds_read_b128 v[170:173], v11 offset:19072
    v_mfma_f32_16x16x32_bf16 v[234:237], v[178:181], v[150:153], v[234:237]
    v_mfma_f32_16x16x32_bf16 v[222:225], v[174:177], a[248:251], v[222:225]
    v_mfma_f32_16x16x32_bf16 v[226:229], v[178:181], a[248:251], v[226:229]
    buffer_load_dwordx4 a[0:3], v6, s[36:39], s4 offen offset:0 sc1
    v_mfma_f32_16x16x32_bf16 v[214:217], v[174:177], a[216:219], v[214:217]
    v_mfma_f32_16x16x32_bf16 v[218:221], v[178:181], a[216:219], v[218:221]
    ds_read_b128 v[174:177], v11 offset:2560
    s_mov_b32 s56, 32768
    buffer_load_dwordx4 v[40:43], v6, s[36:39], s56 offen sc1
    s_waitcnt lgkmcnt(11)
    v_mfma_f32_16x16x32_bf16 v[230:233], v[182:185], v[154:157], v[230:233]
    ds_read_b128 v[178:181], v11 offset:19200
    v_mfma_f32_16x16x32_bf16 v[234:237], v[186:189], v[154:157], v[234:237]
    v_mfma_f32_16x16x32_bf16 v[222:225], v[182:185], a[252:255], v[222:225]
    buffer_load_dwordx4 a[64:67], v6, s[36:39], s5 offen offset:0 sc1
    v_mfma_f32_16x16x32_bf16 v[226:229], v[186:189], a[252:255], v[226:229]
    v_mfma_f32_16x16x32_bf16 v[214:217], v[182:185], a[220:223], v[214:217]
    v_mfma_f32_16x16x32_bf16 v[218:221], v[186:189], a[220:223], v[218:221]
    ds_read_b128 v[182:185], v11 offset:2688
    s_waitcnt lgkmcnt(11)
    v_mfma_f32_16x16x32_bf16 v[230:233], v[190:193], a[224:227], v[230:233]
    ds_read_b128 v[186:189], v11 offset:19328
    s_waitcnt lgkmcnt(8)
    v_mfma_f32_16x16x32_bf16 v[234:237], v[194:197], a[224:227], v[234:237]
    v_lshlrev_b32 v142, 16, v118
    v_and_b32 v143, s51, v118
    buffer_load_dwordx4 a[128:131], v6, s[36:39], s6 offen offset:0 sc1
    v_mfma_f32_16x16x32_bf16 v[222:225], v[190:193], a[192:195], v[222:225]
    v_lshlrev_b32 v144, 16, v119
    v_and_b32 v145, s51, v119
    v_mfma_f32_16x16x32_bf16 v[226:229], v[194:197], a[192:195], v[226:229]
    ds_read_b128 v[190:193], v11 offset:2816
    v_lshlrev_b32 v146, 16, v120
    v_mfma_f32_16x16x32_bf16 v[230:233], v[198:201], a[228:231], v[230:233]
    ds_read_b128 v[194:197], v11 offset:19456
    v_and_b32 v147, s51, v120
    v_mfma_f32_16x16x32_bf16 v[234:237], v[202:205], a[228:231], v[234:237]
    v_lshlrev_b32 v148, 16, v121
    v_and_b32 v149, s51, v121
    v_mfma_f32_16x16x32_bf16 v[222:225], v[198:201], a[196:199], v[222:225]
    v_lshlrev_b32 v150, 16, v122
    v_and_b32 v151, s51, v122
    buffer_load_dwordx4 a[4:7], v6, s[36:39], s4 offen offset:1024 sc1
    v_mfma_f32_16x16x32_bf16 v[226:229], v[202:205], a[196:199], v[226:229]
    ds_read_b128 v[198:201], v11 offset:2944
    v_lshlrev_b32 v152, 16, v123
    s_waitcnt lgkmcnt(9)
    v_mfma_f32_16x16x32_bf16 v[230:233], v[158:161], a[232:235], v[230:233]
    ds_read_b128 v[202:205], v11 offset:19584
    v_and_b32 v153, s51, v123
    v_mfma_f32_16x16x32_bf16 v[234:237], v[162:165], a[232:235], v[234:237]
    v_lshlrev_b32 v154, 16, v124
    v_and_b32 v155, s51, v124
    v_mfma_f32_16x16x32_bf16 v[222:225], v[158:161], a[200:203], v[222:225]
    v_lshlrev_b32 v156, 16, v125
    v_and_b32 v157, s51, v125
    v_mfma_f32_16x16x32_bf16 v[226:229], v[162:165], a[200:203], v[226:229]
    ds_read_b128 v[158:161], v11 offset:3072
    buffer_load_dwordx4 a[68:71], v6, s[36:39], s5 offen offset:1024 sc1
    s_cmp_eq_u32 s71, 1
    s_cbranch_scc1 L_send_18
    ds_write_b128 v20, v[214:217] offset:0
    ds_write_b128 v20, v[218:221] offset:1024
L_send_18:
    s_waitcnt lgkmcnt(9)
    v_mfma_f32_16x16x32_bf16 v[230:233], v[166:169], a[236:239], v[230:233]
    ds_read_b128 v[162:165], v11 offset:19712
    v_mfma_f32_16x16x32_bf16 v[234:237], v[170:173], a[236:239], v[234:237]
    v_mfma_f32_16x16x32_bf16 v[222:225], v[166:169], a[204:207], v[222:225]
    v_mfma_f32_16x16x32_bf16 v[226:229], v[170:173], a[204:207], v[226:229]
    ds_read_b128 v[166:169], v11 offset:3200
    s_waitcnt vmcnt(6)
    s_barrier
    s_waitcnt lgkmcnt(9)
    v_mfma_f32_16x16x32_bf16 v[230:233], v[174:177], a[240:243], v[230:233]
    ds_read_b128 v[170:173], v11 offset:19840
    ds_read_b128 v[102:105], v19 offset:0
    buffer_load_dwordx4 a[132:135], v6, s[36:39], s6 offen offset:1024 sc1
    v_mfma_f32_16x16x32_bf16 v[234:237], v[178:181], a[240:243], v[234:237]
    ds_read_b128 v[86:89], v19 offset:8192
    ds_read_b128 v[106:109], v19 offset:1024
    v_mfma_f32_16x16x32_bf16 v[222:225], v[174:177], a[208:211], v[222:225]
    ds_read_b128 v[90:93], v19 offset:9216
    ds_read_b128 v[110:113], v19 offset:512
    v_mfma_f32_16x16x32_bf16 v[226:229], v[178:181], a[208:211], v[226:229]
    ds_read_b128 v[174:177], v11 offset:3328
    ds_read_b128 v[94:97], v19 offset:8704
    s_waitcnt lgkmcnt(15)
    v_mfma_f32_16x16x32_bf16 v[230:233], v[182:185], a[244:247], v[230:233]
    ds_read_b128 v[178:181], v11 offset:19968
    ds_read_b128 v[114:117], v19 offset:1536
    v_mfma_f32_16x16x32_bf16 v[234:237], v[186:189], a[244:247], v[234:237]
    ds_read_b128 v[98:101], v19 offset:9728
    v_add_f32_dpp v14, v14, v14 quad_perm:[1,0,3,2] row_mask:0xf bank_mask:0xf
    buffer_load_dwordx4 a[8:11], v6, s[36:39], s4 offen offset:2048 sc1
    v_mfma_f32_16x16x32_bf16 v[222:225], v[182:185], a[212:215], v[222:225]
    v_lshlrev_b32 v126, 16, v248
    v_and_b32 v127, s51, v248
    v_mfma_f32_16x16x32_bf16 v[226:229], v[186:189], a[212:215], v[226:229]
    ds_read_b128 v[182:185], v11 offset:3456
    v_add_f32_dpp v14, v14, v14 quad_perm:[2,3,0,1] row_mask:0xf bank_mask:0xf
    s_waitcnt lgkmcnt(15)
    v_mfma_f32_16x16x32_bf16 v[230:233], v[190:193], a[248:251], v[230:233]
    ds_read_b128 v[186:189], v11 offset:20096
    v_cvt_pk_bf16_f32 v14, v14, v14
    v_mfma_f32_16x16x32_bf16 v[234:237], v[194:197], a[248:251], v[234:237]
    v_and_b32 v14, s51, v14
    v_add_f32 v4, 1.0, v14
    v_mfma_f32_16x16x32_bf16 v[222:225], v[190:193], a[216:219], v[222:225]
    v_cvt_pk_bf16_f32 v4, v4, v4
    v_and_b32 v4, s51, v4
    buffer_load_dwordx4 a[72:75], v6, s[36:39], s5 offen offset:2048 sc1
    v_mfma_f32_16x16x32_bf16 v[226:229], v[194:197], a[216:219], v[226:229]
    ds_read_b128 v[190:193], v11 offset:3584
    v_readlane_b32 s62, v14, 0
    s_waitcnt lgkmcnt(15)
    v_mfma_f32_16x16x32_bf16 v[230:233], v[198:201], a[252:255], v[230:233]
    ds_read_b128 v[194:197], v11 offset:20224
    v_readlane_b32 s64, v4, 4
    v_mfma_f32_16x16x32_bf16 v[234:237], v[202:205], a[252:255], v[234:237]
    v_readlane_b32 s66, v14, 8
    v_lshlrev_b32 v128, 16, v249
    v_mfma_f32_16x16x32_bf16 v[222:225], v[198:201], a[220:223], v[222:225]
    v_and_b32 v129, s51, v249
    v_lshlrev_b32 v130, 16, v250
    v_mfma_f32_16x16x32_bf16 v[226:229], v[202:205], a[220:223], v[226:229]
    ds_read_b128 v[198:201], v11 offset:3712
    v_and_b32 v131, s51, v250
    buffer_load_dwordx4 a[136:139], v6, s[36:39], s6 offen offset:2048 sc1
    s_waitcnt lgkmcnt(15)
    v_mfma_f32_16x16x32_bf16 v[230:233], v[158:161], a[192:195], v[230:233]
    ds_read_b128 v[202:205], v11 offset:20352
    v_lshlrev_b32 v132, 16, v251
    v_mfma_f32_16x16x32_bf16 v[234:237], v[162:165], a[192:195], v[234:237]
    ds_read_b128 v[158:161], v11 offset:3840
    v_and_b32 v133, s51, v251
    s_waitcnt lgkmcnt(15)
    v_mfma_f32_16x16x32_bf16 v[230:233], v[166:169], a[196:199], v[230:233]
    ds_read_b128 v[162:165], v11 offset:20480
    v_lshlrev_b32 v134, 16, v252
    v_mfma_f32_16x16x32_bf16 v[234:237], v[170:173], a[196:199], v[234:237]
    ds_read_b128 v[166:169], v11 offset:3968
    v_and_b32 v135, s51, v252
    s_waitcnt lgkmcnt(11)
    v_mfma_f32_16x16x32_bf16 v[230:233], v[174:177], a[200:203], v[230:233]
    ds_read_b128 v[170:173], v11 offset:20608
    v_lshlrev_b32 v136, 16, v253
    buffer_load_dwordx4 a[12:15], v6, s[36:39], s4 offen offset:3072 sc1
    s_add_u32 s4, s4, 4096
    v_mfma_f32_16x16x32_bf16 v[234:237], v[178:181], a[200:203], v[234:237]
    v_and_b32 v137, s51, v253
    v_lshlrev_b32 v138, 16, v254
    s_cmp_eq_u32 s71, 0
    s_cbranch_scc1 L_send_21
    ds_write_b128 v20, v[222:225] offset:2048
    ds_write_b128 v20, v[226:229] offset:3072
L_send_21:
    s_waitcnt lgkmcnt(8)
    v_mfma_f32_16x16x32_bf16 v[230:233], v[182:185], a[204:207], v[230:233]
    v_and_b32 v139, s51, v254
    v_lshlrev_b32 v140, 16, v255
    v_mfma_f32_16x16x32_bf16 v[234:237], v[186:189], a[204:207], v[234:237]
    v_and_b32 v141, s51, v255
    v_mov_b32 v4, s66
    s_waitcnt lgkmcnt(6)
    v_mfma_f32_16x16x32_bf16 v[230:233], v[190:193], a[208:211], v[230:233]
    v_mul_f32 v30, s64, v4
    v_mul_f32 v31, s62, v4
    v_mfma_f32_16x16x32_bf16 v[234:237], v[194:197], a[208:211], v[234:237]
    s_waitcnt vmcnt(9)
    buffer_load_dwordx4 a[76:79], v6, s[36:39], s5 offen offset:3072 sc1
    s_add_u32 s5, s5, 4096
    s_waitcnt lgkmcnt(4)
    v_mfma_f32_16x16x32_bf16 v[230:233], v[198:201], a[212:215], v[230:233]
    v_xor_b32 v40, s52, v40
    v_xor_b32 v41, s52, v41
    v_mfma_f32_16x16x32_bf16 v[234:237], v[202:205], a[212:215], v[234:237]
    v_xor_b32 v42, s52, v42
    v_xor_b32 v43, s52, v43
    s_waitcnt lgkmcnt(2)
    v_mfma_f32_16x16x32_bf16 v[230:233], v[158:161], a[216:219], v[230:233]
    v_or3_b32 v40, v40, v41, v42
    v_or_b32 v40, v40, v43
    v_mfma_f32_16x16x32_bf16 v[234:237], v[162:165], a[216:219], v[234:237]
    v_cmp_ne_u32 vcc, 0, v40
    s_cbranch_vccnz L_slow_19
L_back_20:
    buffer_load_dwordx4 v[32:35], v17, s[36:39], s78 offen sc1
    s_add_u32 s78, s78, 12288
    s_waitcnt lgkmcnt(0)
    v_mfma_f32_16x16x32_bf16 v[230:233], v[166:169], a[220:223], v[230:233]
    v_mfma_f32_16x16x32_bf16 v[234:237], v[170:173], a[220:223], v[234:237]
    s_cmp_eq_u32 s71, 1
    s_cbranch_scc1 L_send_22
    s_nop 4
    ds_write_b128 v20, v[230:233] offset:2048
    ds_write_b128 v20, v[234:237] offset:3072
L_send_22:
    buffer_load_dwordx4 v[36:39], v17, s[36:39], s78 offen sc1
    s_add_u32 s78, s78, 12288
    buffer_load_dwordx4 v[46:49], v17, s[36:39], s78 offen sc1
    s_add_u32 s78, s78, 12288
    buffer_load_dwordx4 v[50:53], v17, s[36:39], s78 offen sc1
    s_mov_b32 m0, 76800
    s_nop 0
    buffer_load_dwordx4 v21, s[36:39], s79 offen sc1 lds
    buffer_load_dwordx4 a[140:143], v6, s[36:39], s6 offen offset:3072 sc1
    s_add_u32 s6, s6, 4096
    buffer_load_dwordx4 a[16:19], v6, s[36:39], s4 offen offset:0 sc1
    buffer_load_dwordx4 a[80:83], v6, s[36:39], s5 offen offset:0 sc1
    buffer_load_dwordx4 a[144:147], v6, s[36:39], s6 offen offset:0 sc1
    s_cmp_eq_u32 s71, 1
    s_cbranch_scc1 L_own_23
    v_pk_fma_f32 v[174:175], v[142:143], s[68:69], v[206:207] op_sel_hi:[1,0,1]
    v_pk_fma_f32 v[176:177], v[144:145], s[68:69], v[208:209] op_sel_hi:[1,0,1]
    v_pk_fma_f32 v[178:179], v[146:147], s[68:69], v[210:211] op_sel_hi:[1,0,1]
    v_pk_fma_f32 v[180:181], v[148:149], s[68:69], v[212:213] op_sel_hi:[1,0,1]
    v_pk_fma_f32 v[182:183], v[150:151], s[68:69], v[222:223] op_sel_hi:[1,0,1]
    v_pk_fma_f32 v[184:185], v[152:153], s[68:69], v[224:225] op_sel_hi:[1,0,1]
    v_pk_fma_f32 v[186:187], v[154:155], s[68:69], v[226:227] op_sel_hi:[1,0,1]
    v_pk_fma_f32 v[188:189], v[156:157], s[68:69], v[228:229] op_sel_hi:[1,0,1]
    s_branch L_ownd_24
L_own_23:
    v_pk_fma_f32 v[174:175], v[142:143], s[68:69], v[214:215] op_sel_hi:[1,0,1]
    v_pk_fma_f32 v[176:177], v[144:145], s[68:69], v[216:217] op_sel_hi:[1,0,1]
    v_pk_fma_f32 v[178:179], v[146:147], s[68:69], v[218:219] op_sel_hi:[1,0,1]
    v_pk_fma_f32 v[180:181], v[148:149], s[68:69], v[220:221] op_sel_hi:[1,0,1]
    v_pk_fma_f32 v[182:183], v[150:151], s[68:69], v[230:231] op_sel_hi:[1,0,1]
    v_pk_fma_f32 v[184:185], v[152:153], s[68:69], v[232:233] op_sel_hi:[1,0,1]
    v_pk_fma_f32 v[186:187], v[154:155], s[68:69], v[234:235] op_sel_hi:[1,0,1]
    v_pk_fma_f32 v[188:189], v[156:157], s[68:69], v[236:237] op_sel_hi:[1,0,1]
L_ownd_24:
    s_waitcnt lgkmcnt(0)
    s_barrier
    v_xor_b32 v20, 4096, v20
    ds_read_b128 v[190:193], v20 offset:0
    ds_read_b128 v[194:197], v20 offset:1024
    ds_read_b128 v[198:201], v20 offset:2048
    ds_read_b128 v[202:205], v20 offset:3072
    v_pk_mul_f32 v[102:103], v[102:103], v[30:31] op_sel_hi:[1,0]
    v_pk_fma_f32 v[86:87], v[86:87], v[30:31], v[30:31] op_sel:[0,0,1] op_sel_hi:[1,0,1]
    v_pk_mul_f32 v[104:105], v[104:105], v[30:31] op_sel_hi:[1,0]
    v_pk_fma_f32 v[88:89], v[88:89], v[30:31], v[30:31] op_sel:[0,0,1] op_sel_hi:[1,0,1]
    v_pk_mul_f32 v[106:107], v[106:107], v[30:31] op_sel_hi:[1,0]
    v_pk_fma_f32 v[90:91], v[90:91], v[30:31], v[30:31] op_sel:[0,0,1] op_sel_hi:[1,0,1]
    v_pk_mul_f32 v[108:109], v[108:109], v[30:31] op_sel_hi:[1,0]
    v_pk_fma_f32 v[92:93], v[92:93], v[30:31], v[30:31] op_sel:[0,0,1] op_sel_hi:[1,0,1]
    v_pk_mul_f32 v[110:111], v[110:111], v[30:31] op_sel_hi:[1,0]
    v_pk_fma_f32 v[94:95], v[94:95], v[30:31], v[30:31] op_sel:[0,0,1] op_sel_hi:[1,0,1]
    v_pk_mul_f32 v[112:113], v[112:113], v[30:31] op_sel_hi:[1,0]
    v_pk_fma_f32 v[96:97], v[96:97], v[30:31], v[30:31] op_sel:[0,0,1] op_sel_hi:[1,0,1]
    v_pk_mul_f32 v[114:115], v[114:115], v[30:31] op_sel_hi:[1,0]
    v_pk_fma_f32 v[98:99], v[98:99], v[30:31], v[30:31] op_sel:[0,0,1] op_sel_hi:[1,0,1]
    v_pk_mul_f32 v[116:117], v[116:117], v[30:31] op_sel_hi:[1,0]
    v_pk_fma_f32 v[100:101], v[100:101], v[30:31], v[30:31] op_sel:[0,0,1] op_sel_hi:[1,0,1]
    v_pk_fma_f32 v[86:87], v[126:127], v[102:103], v[86:87]
    v_pk_fma_f32 v[88:89], v[128:129], v[104:105], v[88:89]
    v_pk_fma_f32 v[90:91], v[130:131], v[106:107], v[90:91]
    v_pk_fma_f32 v[92:93], v[132:133], v[108:109], v[92:93]
    v_pk_fma_f32 v[94:95], v[134:135], v[110:111], v[94:95]
    v_pk_fma_f32 v[96:97], v[136:137], v[112:113], v[96:97]
    v_pk_fma_f32 v[98:99], v[138:139], v[114:115], v[98:99]
    v_pk_fma_f32 v[100:101], v[140:141], v[116:117], v[100:101]
    s_waitcnt lgkmcnt(2)
    v_pk_add_f32 v[190:191], v[190:191], v[174:175]
    v_pk_add_f32 v[192:193], v[192:193], v[176:177]
    v_pk_add_f32 v[194:195], v[194:195], v[178:179]
    v_pk_add_f32 v[196:197], v[196:197], v[180:181]
    v_pk_fma_f32 v[190:191], v[190:191], v[86:87], v[126:127]
    v_pk_fma_f32 v[192:193], v[192:193], v[88:89], v[128:129]
    v_pk_fma_f32 v[194:195], v[194:195], v[90:91], v[130:131]
    v_pk_fma_f32 v[196:197], v[196:197], v[92:93], v[132:133]
    v_cvt_pk_bf16_f32 v248, v190, v191
    v_cvt_pk_bf16_f32 v249, v192, v193
    v_cvt_pk_bf16_f32 v250, v194, v195
    v_cvt_pk_bf16_f32 v251, v196, v197
    buffer_store_dwordx4 v[248:251], v6, s[36:39], s42 offen offset:0 sc1
    s_waitcnt lgkmcnt(0)
    v_pk_add_f32 v[198:199], v[198:199], v[182:183]
    v_pk_add_f32 v[200:201], v[200:201], v[184:185]
    v_pk_add_f32 v[202:203], v[202:203], v[186:187]
    v_pk_add_f32 v[204:205], v[204:205], v[188:189]
    v_pk_fma_f32 v[198:199], v[198:199], v[94:95], v[134:135]
    v_pk_fma_f32 v[200:201], v[200:201], v[96:97], v[136:137]
    v_pk_fma_f32 v[202:203], v[202:203], v[98:99], v[138:139]
    v_pk_fma_f32 v[204:205], v[204:205], v[100:101], v[140:141]
    v_cvt_pk_bf16_f32 v252, v198, v199
    v_cvt_pk_bf16_f32 v253, v200, v201
    v_cvt_pk_bf16_f32 v254, v202, v203
    v_cvt_pk_bf16_f32 v255, v204, v205
    buffer_store_dwordx4 v[252:255], v6, s[36:39], s42 offen offset:2048 sc1
    buffer_load_dwordx4 a[20:23], v6, s[36:39], s4 offen offset:1024 sc1
    buffer_load_dwordx4 a[84:87], v6, s[36:39], s5 offen offset:1024 sc1
    buffer_load_dwordx4 a[148:151], v6, s[36:39], s6 offen offset:1024 sc1
    buffer_load_dwordx4 a[24:27], v6, s[36:39], s4 offen offset:2048 sc1
    s_waitcnt vmcnt(10)
    v_pk_add_f32 v[32:33], v[32:33], v[36:37]
    v_pk_add_f32 v[34:35], v[34:35], v[38:39]
    v_pk_add_f32 v[32:33], v[32:33], v[46:47]
    v_pk_add_f32 v[34:35], v[34:35], v[48:49]
    v_pk_add_f32 v[32:33], v[32:33], v[50:51]
    v_pk_add_f32 v[34:35], v[34:35], v[52:53]
    v_cvt_pk_bf16_f32 v36, v32, v33
    v_cvt_pk_bf16_f32 v37, v34, v35
    v_lshlrev_b32 v32, 16, v36
    v_and_b32 v33, s51, v36
    v_lshlrev_b32 v34, 16, v37
    v_and_b32 v35, s51, v37
    s_cmp_lt_u32 s48, 2
    s_cselect_b32 s54, 1.0, 0
    v_add_f32 v32, s54, v32
    v_add_f32 v33, s54, v33
    v_add_f32 v34, s54, v34
    v_add_f32 v35, s54, v35
    v_cvt_pk_bf16_f32 v36, v32, v33
    v_cvt_pk_bf16_f32 v37, v34, v35
    v_lshlrev_b32 v4, 3, v0
    v_add_u32 v4, 77824, v4
    ds_write_b64 v4, v[36:37]
    s_waitcnt lgkmcnt(0)
    s_barrier
    v_mov_b32 v30, 0
    v_mov_b32 v31, 0
    v_mov_b32 v36, 0
    v_mov_b32 v37, 0
    ds_read_b128 v[12:15], v9 offset:0
    ds_read_b128 v[20:23], v10 offset:0
    s_cmp_eq_u32 s48, 3
    s_cselect_b32 s54, 1.0, 0
    v_mov_b32 v16, s54
    v_mov_b32 v17, s54
    v_mov_b32 v18, s54
    v_mov_b32 v19, s54
    v_lshrrev_b32 v188, 3, v1
    v_lshlrev_b32 v188, 12, v188
    v_and_b32 v5, 7, v1
    v_and_b32 v189, 1, v3
    v_lshlrev_b32 v189, 1, v189
    v_xor_b32 v5, v5, v189
    v_lshl_add_u32 v188, v5, 4, v188
    v_xor_b32 v189, 64, v188
    s_waitcnt lgkmcnt(0)
    v_and_b32 v28, v12, v7
    v_and_b32 v29, v13, v8
    v_and_b32 v32, v14, v7
    v_and_b32 v33, v15, v8
    v_mfma_f32_16x16x32_bf16 a[244:247], a[0:3], v[20:23], 0
    buffer_load_dwordx4 a[88:91], v6, s[36:39], s5 offen offset:2048 sc1
    ds_read_b128 v[12:15], v9 offset:64
    ds_read_b128 v[24:27], v10 offset:64
    v_mfma_f32_16x16x32_bf16 v[40:43], v[28:31], a[0:3], 0
    v_mfma_f32_16x16x32_bf16 v[44:47], v[30:33], a[0:3], 0
    v_mfma_f32_16x16x32_bf16 a[248:251], a[64:67], v[20:23], 0
    buffer_load_dwordx4 a[152:155], v6, s[36:39], s6 offen offset:2048 sc1
    v_mfma_f32_16x16x32_bf16 v[48:51], v[28:31], a[64:67], 0
    v_mfma_f32_16x16x32_bf16 v[52:55], v[30:33], a[64:67], 0
    s_waitcnt vmcnt(6)
    s_mov_b64 exec, 1
    v_mov_b32 v4, 156936
    v_mov_b32 v5, 1
    ds_add_rtn_u32 v5, v4, v5
    s_lshl_b32 s54, s3, 2
    s_add_u32 s54, s54, 40960
    v_mov_b32 v4, s52
    s_waitcnt lgkmcnt(0)
    v_readfirstlane_b32 s55, v5
    v_mov_b32 v5, s44
    s_cmp_lg_u32 s55, 3
    s_cbranch_scc1 L_sig_25
    buffer_store_dword v4, v1, s[36:39], s54 offen sc1
L_sig_25:
    s_mov_b64 exec, -1
    v_mfma_f32_16x16x32_bf16 a[252:255], a[128:131], v[20:23], 0
    buffer_load_dwordx4 a[28:31], v6, s[36:39], s4 offen offset:3072 sc1
    s_add_u32 s4, s4, 4096
    v_mfma_f32_16x16x32_bf16 v[56:59], v[28:31], a[128:131], v[16:19]
    v_cvt_pk_bf16_f32 v64, v40, v41
    v_cvt_pk_bf16_f32 v65, v42, v43
    v_mfma_f32_16x16x32_bf16 v[60:63], v[30:33], a[128:131], v[16:19]
    v_cvt_pk_bf16_f32 v66, v44, v45
    v_cvt_pk_bf16_f32 v67, v46, v47
    v_and_b32 v34, v12, v7
    v_and_b32 v35, v13, v8
    v_and_b32 v38, v14, v7
    v_and_b32 v39, v15, v8
    v_mfma_f32_16x16x32_bf16 a[244:247], a[4:7], v[24:27], a[244:247]
    buffer_load_dwordx4 a[92:95], v6, s[36:39], s5 offen offset:3072 sc1
    s_add_u32 s5, s5, 4096
    ds_read_b128 v[12:15], v9 offset:128
    ds_read_b128 v[20:23], v10 offset:128
    v_mfma_f32_16x16x32_bf16 v[40:43], v[34:37], a[4:7], 0
    v_cvt_pk_bf16_f32 v128, v48, v49
    v_cvt_pk_bf16_f32 v129, v50, v51
    v_mfma_f32_16x16x32_bf16 v[44:47], v[36:39], a[4:7], 0
    v_cvt_pk_bf16_f32 v130, v52, v53
    v_cvt_pk_bf16_f32 v131, v54, v55
    v_mfma_f32_16x16x32_bf16 a[248:251], a[68:71], v[24:27], a[248:251]
    buffer_load_dwordx4 a[156:159], v6, s[36:39], s6 offen offset:3072 sc1
    s_add_u32 s6, s6, 4096
    v_mfma_f32_16x16x32_bf16 v[48:51], v[34:37], a[68:71], 0
    v_cvt_pk_bf16_f32 v192, v56, v57
    v_cvt_pk_bf16_f32 v193, v58, v59
    v_mfma_f32_16x16x32_bf16 v[52:55], v[36:39], a[68:71], 0
    v_cvt_pk_bf16_f32 v194, v60, v61
    v_cvt_pk_bf16_f32 v195, v62, v63
    v_mfma_f32_16x16x32_bf16 a[252:255], a[132:135], v[24:27], a[252:255]
    buffer_load_dwordx4 a[32:35], v6, s[36:39], s4 offen offset:0 sc1
    v_mfma_f32_16x16x32_bf16 v[56:59], v[34:37], a[132:135], v[16:19]
    v_cvt_pk_bf16_f32 v68, v40, v41
    v_cvt_pk_bf16_f32 v69, v42, v43
    v_mfma_f32_16x16x32_bf16 v[60:63], v[36:39], a[132:135], v[16:19]
    v_cvt_pk_bf16_f32 v70, v44, v45
    v_cvt_pk_bf16_f32 v71, v46, v47
    s_waitcnt lgkmcnt(0)
    v_and_b32 v28, v12, v7
    v_and_b32 v29, v13, v8
    v_and_b32 v32, v14, v7
    v_and_b32 v33, v15, v8
    v_mfma_f32_16x16x32_bf16 a[244:247], a[8:11], v[20:23], a[244:247]
    buffer_load_dwordx4 a[96:99], v6, s[36:39], s5 offen offset:0 sc1
    ds_read_b128 v[12:15], v9 offset:192
    ds_read_b128 v[24:27], v10 offset:192
    v_mfma_f32_16x16x32_bf16 v[40:43], v[28:31], a[8:11], 0
    v_cvt_pk_bf16_f32 v132, v48, v49
    v_cvt_pk_bf16_f32 v133, v50, v51
    v_mfma_f32_16x16x32_bf16 v[44:47], v[30:33], a[8:11], 0
    v_cvt_pk_bf16_f32 v134, v52, v53
    v_cvt_pk_bf16_f32 v135, v54, v55
    v_mfma_f32_16x16x32_bf16 a[248:251], a[72:75], v[20:23], a[248:251]
    buffer_load_dwordx4 a[160:163], v6, s[36:39], s6 offen offset:0 sc1
    v_mfma_f32_16x16x32_bf16 v[48:51], v[28:31], a[72:75], 0
    v_cvt_pk_bf16_f32 v196, v56, v57
    v_cvt_pk_bf16_f32 v197, v58, v59
    v_mfma_f32_16x16x32_bf16 v[52:55], v[30:33], a[72:75], 0
    v_cvt_pk_bf16_f32 v198, v60, v61
    v_cvt_pk_bf16_f32 v199, v62, v63
    v_mfma_f32_16x16x32_bf16 a[252:255], a[136:139], v[20:23], a[252:255]
    buffer_load_dwordx4 a[36:39], v6, s[36:39], s4 offen offset:1024 sc1
    v_mfma_f32_16x16x32_bf16 v[56:59], v[28:31], a[136:139], v[16:19]
    v_cvt_pk_bf16_f32 v72, v40, v41
    v_cvt_pk_bf16_f32 v73, v42, v43
    v_mfma_f32_16x16x32_bf16 v[60:63], v[30:33], a[136:139], v[16:19]
    v_cvt_pk_bf16_f32 v74, v44, v45
    v_cvt_pk_bf16_f32 v75, v46, v47
    s_waitcnt lgkmcnt(0)
    v_and_b32 v34, v12, v7
    v_and_b32 v35, v13, v8
    v_and_b32 v38, v14, v7
    v_and_b32 v39, v15, v8
    v_mfma_f32_16x16x32_bf16 a[244:247], a[12:15], v[24:27], a[244:247]
    buffer_load_dwordx4 a[100:103], v6, s[36:39], s5 offen offset:1024 sc1
    ds_read_b128 v[12:15], v9 offset:256
    ds_read_b128 v[20:23], v10 offset:256
    v_mfma_f32_16x16x32_bf16 v[40:43], v[34:37], a[12:15], 0
    v_cvt_pk_bf16_f32 v136, v48, v49
    v_cvt_pk_bf16_f32 v137, v50, v51
    v_mfma_f32_16x16x32_bf16 v[44:47], v[36:39], a[12:15], 0
    v_cvt_pk_bf16_f32 v138, v52, v53
    v_cvt_pk_bf16_f32 v139, v54, v55
    v_mfma_f32_16x16x32_bf16 a[248:251], a[76:79], v[24:27], a[248:251]
    buffer_load_dwordx4 a[164:167], v6, s[36:39], s6 offen offset:1024 sc1
    v_mfma_f32_16x16x32_bf16 v[48:51], v[34:37], a[76:79], 0
    v_cvt_pk_bf16_f32 v200, v56, v57
    v_cvt_pk_bf16_f32 v201, v58, v59
    v_mfma_f32_16x16x32_bf16 v[52:55], v[36:39], a[76:79], 0
    v_cvt_pk_bf16_f32 v202, v60, v61
    v_cvt_pk_bf16_f32 v203, v62, v63
    v_mfma_f32_16x16x32_bf16 a[252:255], a[140:143], v[24:27], a[252:255]
    buffer_load_dwordx4 a[40:43], v6, s[36:39], s4 offen offset:2048 sc1
    v_mfma_f32_16x16x32_bf16 v[56:59], v[34:37], a[140:143], v[16:19]
    v_cvt_pk_bf16_f32 v76, v40, v41
    v_cvt_pk_bf16_f32 v77, v42, v43
    v_mfma_f32_16x16x32_bf16 v[60:63], v[36:39], a[140:143], v[16:19]
    v_cvt_pk_bf16_f32 v78, v44, v45
    v_cvt_pk_bf16_f32 v79, v46, v47
    s_waitcnt lgkmcnt(0)
    v_and_b32 v28, v12, v7
    v_and_b32 v29, v13, v8
    v_and_b32 v32, v14, v7
    v_and_b32 v33, v15, v8
    v_mfma_f32_16x16x32_bf16 a[244:247], a[16:19], v[20:23], a[244:247]
    buffer_load_dwordx4 a[104:107], v6, s[36:39], s5 offen offset:2048 sc1
    ds_read_b128 v[12:15], v9 offset:320
    ds_read_b128 v[24:27], v10 offset:320
    v_mfma_f32_16x16x32_bf16 v[40:43], v[28:31], a[16:19], 0
    v_cvt_pk_bf16_f32 v140, v48, v49
    v_cvt_pk_bf16_f32 v141, v50, v51
    v_mfma_f32_16x16x32_bf16 v[44:47], v[30:33], a[16:19], 0
    v_cvt_pk_bf16_f32 v142, v52, v53
    v_cvt_pk_bf16_f32 v143, v54, v55
    v_mfma_f32_16x16x32_bf16 a[248:251], a[80:83], v[20:23], a[248:251]
    buffer_load_dwordx4 a[168:171], v6, s[36:39], s6 offen offset:2048 sc1
    v_mfma_f32_16x16x32_bf16 v[48:51], v[28:31], a[80:83], 0
    v_cvt_pk_bf16_f32 v204, v56, v57
    v_cvt_pk_bf16_f32 v205, v58, v59
    v_mfma_f32_16x16x32_bf16 v[52:55], v[30:33], a[80:83], 0
    v_cvt_pk_bf16_f32 v206, v60, v61
    v_cvt_pk_bf16_f32 v207, v62, v63
    v_mfma_f32_16x16x32_bf16 a[252:255], a[144:147], v[20:23], a[252:255]
    buffer_load_dwordx4 a[44:47], v6, s[36:39], s4 offen offset:3072 sc1
    s_add_u32 s4, s4, 4096
    v_mfma_f32_16x16x32_bf16 v[56:59], v[28:31], a[144:147], v[16:19]
    v_cvt_pk_bf16_f32 v80, v40, v41
    v_cvt_pk_bf16_f32 v81, v42, v43
    v_mfma_f32_16x16x32_bf16 v[60:63], v[30:33], a[144:147], v[16:19]
    v_cvt_pk_bf16_f32 v82, v44, v45
    v_cvt_pk_bf16_f32 v83, v46, v47
    s_waitcnt lgkmcnt(0)
    v_and_b32 v34, v12, v7
    v_and_b32 v35, v13, v8
    v_and_b32 v38, v14, v7
    v_and_b32 v39, v15, v8
    s_waitcnt vmcnt(16)
    v_mfma_f32_16x16x32_bf16 a[244:247], a[20:23], v[24:27], a[244:247]
    buffer_load_dwordx4 a[108:111], v6, s[36:39], s5 offen offset:3072 sc1
    s_add_u32 s5, s5, 4096
    ds_read_b128 v[12:15], v9 offset:384
    ds_read_b128 v[20:23], v10 offset:384
    v_mfma_f32_16x16x32_bf16 v[40:43], v[34:37], a[20:23], 0
    v_cvt_pk_bf16_f32 v144, v48, v49
    v_cvt_pk_bf16_f32 v145, v50, v51
    v_mfma_f32_16x16x32_bf16 v[44:47], v[36:39], a[20:23], 0
    v_cvt_pk_bf16_f32 v146, v52, v53
    v_cvt_pk_bf16_f32 v147, v54, v55
    v_mfma_f32_16x16x32_bf16 a[248:251], a[84:87], v[24:27], a[248:251]
    buffer_load_dwordx4 a[172:175], v6, s[36:39], s6 offen offset:3072 sc1
    s_add_u32 s6, s6, 4096
    v_mfma_f32_16x16x32_bf16 v[48:51], v[34:37], a[84:87], 0
    v_cvt_pk_bf16_f32 v208, v56, v57
    v_cvt_pk_bf16_f32 v209, v58, v59
    v_mfma_f32_16x16x32_bf16 v[52:55], v[36:39], a[84:87], 0
    v_cvt_pk_bf16_f32 v210, v60, v61
    v_cvt_pk_bf16_f32 v211, v62, v63
    v_mfma_f32_16x16x32_bf16 a[252:255], a[148:151], v[24:27], a[252:255]
    buffer_load_dwordx4 a[48:51], v6, s[36:39], s4 offen offset:0 sc1
    v_mfma_f32_16x16x32_bf16 v[56:59], v[34:37], a[148:151], v[16:19]
    v_cvt_pk_bf16_f32 v84, v40, v41
    v_cvt_pk_bf16_f32 v85, v42, v43
    v_mfma_f32_16x16x32_bf16 v[60:63], v[36:39], a[148:151], v[16:19]
    v_cvt_pk_bf16_f32 v86, v44, v45
    v_cvt_pk_bf16_f32 v87, v46, v47
    s_waitcnt lgkmcnt(0)
    v_and_b32 v28, v12, v7
    v_and_b32 v29, v13, v8
    v_and_b32 v32, v14, v7
    v_and_b32 v33, v15, v8
    s_waitcnt vmcnt(16)
    v_mfma_f32_16x16x32_bf16 a[244:247], a[24:27], v[20:23], a[244:247]
    buffer_load_dwordx4 a[112:115], v6, s[36:39], s5 offen offset:0 sc1
    ds_read_b128 v[12:15], v9 offset:448
    ds_read_b128 v[24:27], v10 offset:448
    v_mfma_f32_16x16x32_bf16 v[40:43], v[28:31], a[24:27], 0
    v_cvt_pk_bf16_f32 v148, v48, v49
    v_cvt_pk_bf16_f32 v149, v50, v51
    v_mfma_f32_16x16x32_bf16 v[44:47], v[30:33], a[24:27], 0
    v_cvt_pk_bf16_f32 v150, v52, v53
    v_cvt_pk_bf16_f32 v151, v54, v55
    v_mfma_f32_16x16x32_bf16 a[248:251], a[88:91], v[20:23], a[248:251]
    buffer_load_dwordx4 a[176:179], v6, s[36:39], s6 offen offset:0 sc1
    v_mfma_f32_16x16x32_bf16 v[48:51], v[28:31], a[88:91], 0
    v_cvt_pk_bf16_f32 v212, v56, v57
    v_cvt_pk_bf16_f32 v213, v58, v59
    v_mfma_f32_16x16x32_bf16 v[52:55], v[30:33], a[88:91], 0
    v_cvt_pk_bf16_f32 v214, v60, v61
    v_cvt_pk_bf16_f32 v215, v62, v63
    v_mfma_f32_16x16x32_bf16 a[252:255], a[152:155], v[20:23], a[252:255]
    buffer_load_dwordx4 a[52:55], v6, s[36:39], s4 offen offset:1024 sc1
    v_mfma_f32_16x16x32_bf16 v[56:59], v[28:31], a[152:155], v[16:19]
    v_cvt_pk_bf16_f32 v88, v40, v41
    v_cvt_pk_bf16_f32 v89, v42, v43
    v_mfma_f32_16x16x32_bf16 v[60:63], v[30:33], a[152:155], v[16:19]
    v_cvt_pk_bf16_f32 v90, v44, v45
    v_cvt_pk_bf16_f32 v91, v46, v47
    s_waitcnt lgkmcnt(0)
    v_and_b32 v34, v12, v7
    v_and_b32 v35, v13, v8
    v_and_b32 v38, v14, v7
    v_and_b32 v39, v15, v8
    s_waitcnt vmcnt(16)
    v_mfma_f32_16x16x32_bf16 a[244:247], a[28:31], v[24:27], a[244:247]
    buffer_load_dwordx4 a[116:119], v6, s[36:39], s5 offen offset:1024 sc1
    ds_read_b128 v[12:15], v9 offset:512
    ds_read_b128 v[20:23], v10 offset:512
    v_mfma_f32_16x16x32_bf16 v[40:43], v[34:37], a[28:31], 0
    v_cvt_pk_bf16_f32 v152, v48, v49
    v_cvt_pk_bf16_f32 v153, v50, v51
    v_mfma_f32_16x16x32_bf16 v[44:47], v[36:39], a[28:31], 0
    v_cvt_pk_bf16_f32 v154, v52, v53
    v_cvt_pk_bf16_f32 v155, v54, v55
    v_mfma_f32_16x16x32_bf16 a[248:251], a[92:95], v[24:27], a[248:251]
    buffer_load_dwordx4 a[180:183], v6, s[36:39], s6 offen offset:1024 sc1
    v_mfma_f32_16x16x32_bf16 v[48:51], v[34:37], a[92:95], 0
    v_cvt_pk_bf16_f32 v216, v56, v57
    v_cvt_pk_bf16_f32 v217, v58, v59
    v_mfma_f32_16x16x32_bf16 v[52:55], v[36:39], a[92:95], 0
    v_cvt_pk_bf16_f32 v218, v60, v61
    v_cvt_pk_bf16_f32 v219, v62, v63
    v_mfma_f32_16x16x32_bf16 a[252:255], a[156:159], v[24:27], a[252:255]
    buffer_load_dwordx4 a[56:59], v6, s[36:39], s4 offen offset:2048 sc1
    v_mfma_f32_16x16x32_bf16 v[56:59], v[34:37], a[156:159], v[16:19]
    v_cvt_pk_bf16_f32 v92, v40, v41
    v_cvt_pk_bf16_f32 v93, v42, v43
    v_mfma_f32_16x16x32_bf16 v[60:63], v[36:39], a[156:159], v[16:19]
    v_cvt_pk_bf16_f32 v94, v44, v45
    v_cvt_pk_bf16_f32 v95, v46, v47
    s_waitcnt lgkmcnt(0)
    v_and_b32 v28, v12, v7
    v_and_b32 v29, v13, v8
    v_and_b32 v32, v14, v7
    v_and_b32 v33, v15, v8
    s_waitcnt vmcnt(16)
    v_mfma_f32_16x16x32_bf16 a[244:247], a[32:35], v[20:23], a[244:247]
    buffer_load_dwordx4 a[120:123], v6, s[36:39], s5 offen offset:2048 sc1
    ds_read_b128 v[12:15], v9 offset:576
    ds_read_b128 v[24:27], v10 offset:576
    v_mfma_f32_16x16x32_bf16 v[40:43], v[28:31], a[32:35], 0
    v_cvt_pk_bf16_f32 v156, v48, v49
    v_cvt_pk_bf16_f32 v157, v50, v51
    v_mfma_f32_16x16x32_bf16 v[44:47], v[30:33], a[32:35], 0
    v_cvt_pk_bf16_f32 v158, v52, v53
    v_cvt_pk_bf16_f32 v159, v54, v55
    v_mfma_f32_16x16x32_bf16 a[248:251], a[96:99], v[20:23], a[248:251]
    buffer_load_dwordx4 a[184:187], v6, s[36:39], s6 offen offset:2048 sc1
    v_mfma_f32_16x16x32_bf16 v[48:51], v[28:31], a[96:99], 0
    v_cvt_pk_bf16_f32 v220, v56, v57
    v_cvt_pk_bf16_f32 v221, v58, v59
    v_mfma_f32_16x16x32_bf16 v[52:55], v[30:33], a[96:99], 0
    v_cvt_pk_bf16_f32 v222, v60, v61
    v_cvt_pk_bf16_f32 v223, v62, v63
    v_mfma_f32_16x16x32_bf16 a[252:255], a[160:163], v[20:23], a[252:255]
    buffer_load_dwordx4 a[60:63], v6, s[36:39], s4 offen offset:3072 sc1
    v_mfma_f32_16x16x32_bf16 v[56:59], v[28:31], a[160:163], v[16:19]
    v_cvt_pk_bf16_f32 v96, v40, v41
    v_cvt_pk_bf16_f32 v97, v42, v43
    v_mfma_f32_16x16x32_bf16 v[60:63], v[30:33], a[160:163], v[16:19]
    v_cvt_pk_bf16_f32 v98, v44, v45
    v_cvt_pk_bf16_f32 v99, v46, v47
    s_waitcnt lgkmcnt(0)
    v_and_b32 v34, v12, v7
    v_and_b32 v35, v13, v8
    v_and_b32 v38, v14, v7
    v_and_b32 v39, v15, v8
    s_waitcnt vmcnt(16)
    v_mfma_f32_16x16x32_bf16 a[244:247], a[36:39], v[24:27], a[244:247]
    buffer_load_dwordx4 a[124:127], v6, s[36:39], s5 offen offset:3072 sc1
    ds_read_b128 v[12:15], v9 offset:640
    ds_read_b128 v[20:23], v10 offset:640
    v_mfma_f32_16x16x32_bf16 v[40:43], v[34:37], a[36:39], 0
    v_cvt_pk_bf16_f32 v160, v48, v49
    v_cvt_pk_bf16_f32 v161, v50, v51
    v_mfma_f32_16x16x32_bf16 v[44:47], v[36:39], a[36:39], 0
    v_cvt_pk_bf16_f32 v162, v52, v53
    v_cvt_pk_bf16_f32 v163, v54, v55
    v_mfma_f32_16x16x32_bf16 a[248:251], a[100:103], v[24:27], a[248:251]
    buffer_load_dwordx4 a[188:191], v6, s[36:39], s6 offen offset:3072 sc1
    v_mfma_f32_16x16x32_bf16 v[48:51], v[34:37], a[100:103], 0
    v_cvt_pk_bf16_f32 v224, v56, v57
    v_cvt_pk_bf16_f32 v225, v58, v59
    v_mfma_f32_16x16x32_bf16 v[52:55], v[36:39], a[100:103], 0
    v_cvt_pk_bf16_f32 v226, v60, v61
    v_cvt_pk_bf16_f32 v227, v62, v63
    v_mfma_f32_16x16x32_bf16 a[252:255], a[164:167], v[24:27], a[252:255]
    v_mfma_f32_16x16x32_bf16 v[56:59], v[34:37], a[164:167], v[16:19]
    v_cvt_pk_bf16_f32 v100, v40, v41
    v_cvt_pk_bf16_f32 v101, v42, v43
    v_mfma_f32_16x16x32_bf16 v[60:63], v[36:39], a[164:167], v[16:19]
    v_cvt_pk_bf16_f32 v102, v44, v45
    v_cvt_pk_bf16_f32 v103, v46, v47
    s_waitcnt lgkmcnt(0)
    v_and_b32 v28, v12, v7
    v_and_b32 v29, v13, v8
    v_and_b32 v32, v14, v7
    v_and_b32 v33, v15, v8
    s_waitcnt vmcnt(15)
    v_mfma_f32_16x16x32_bf16 a[244:247], a[40:43], v[20:23], a[244:247]
    ds_read_b128 v[12:15], v9 offset:704
    ds_read_b128 v[24:27], v10 offset:704
    v_mfma_f32_16x16x32_bf16 v[40:43], v[28:31], a[40:43], 0
    v_cvt_pk_bf16_f32 v164, v48, v49
    v_cvt_pk_bf16_f32 v165, v50, v51
    v_mfma_f32_16x16x32_bf16 v[44:47], v[30:33], a[40:43], 0
    v_cvt_pk_bf16_f32 v166, v52, v53
    v_cvt_pk_bf16_f32 v167, v54, v55
    v_mfma_f32_16x16x32_bf16 a[248:251], a[104:107], v[20:23], a[248:251]
    v_mfma_f32_16x16x32_bf16 v[48:51], v[28:31], a[104:107], 0
    v_cvt_pk_bf16_f32 v228, v56, v57
    v_cvt_pk_bf16_f32 v229, v58, v59
    v_mfma_f32_16x16x32_bf16 v[52:55], v[30:33], a[104:107], 0
    v_cvt_pk_bf16_f32 v230, v60, v61
    v_cvt_pk_bf16_f32 v231, v62, v63
    v_mfma_f32_16x16x32_bf16 a[252:255], a[168:171], v[20:23], a[252:255]
    v_mfma_f32_16x16x32_bf16 v[56:59], v[28:31], a[168:171], v[16:19]
    v_cvt_pk_bf16_f32 v104, v40, v41
    v_cvt_pk_bf16_f32 v105, v42, v43
    v_mfma_f32_16x16x32_bf16 v[60:63], v[30:33], a[168:171], v[16:19]
    v_cvt_pk_bf16_f32 v106, v44, v45
    v_cvt_pk_bf16_f32 v107, v46, v47
    s_waitcnt lgkmcnt(0)
    v_and_b32 v34, v12, v7
    v_and_b32 v35, v13, v8
    v_and_b32 v38, v14, v7
    v_and_b32 v39, v15, v8
    s_waitcnt vmcnt(12)
    v_mfma_f32_16x16x32_bf16 a[244:247], a[44:47], v[24:27], a[244:247]
    ds_read_b128 v[12:15], v9 offset:768
    ds_read_b128 v[20:23], v10 offset:768
    v_mfma_f32_16x16x32_bf16 v[40:43], v[34:37], a[44:47], 0
    v_cvt_pk_bf16_f32 v168, v48, v49
    v_cvt_pk_bf16_f32 v169, v50, v51
    v_mfma_f32_16x16x32_bf16 v[44:47], v[36:39], a[44:47], 0
    v_cvt_pk_bf16_f32 v170, v52, v53
    v_cvt_pk_bf16_f32 v171, v54, v55
    v_mfma_f32_16x16x32_bf16 a[248:251], a[108:111], v[24:27], a[248:251]
    v_mfma_f32_16x16x32_bf16 v[48:51], v[34:37], a[108:111], 0
    v_cvt_pk_bf16_f32 v232, v56, v57
    v_cvt_pk_bf16_f32 v233, v58, v59
    v_mfma_f32_16x16x32_bf16 v[52:55], v[36:39], a[108:111], 0
    v_cvt_pk_bf16_f32 v234, v60, v61
    v_cvt_pk_bf16_f32 v235, v62, v63
    v_mfma_f32_16x16x32_bf16 a[252:255], a[172:175], v[24:27], a[252:255]
    v_mfma_f32_16x16x32_bf16 v[56:59], v[34:37], a[172:175], v[16:19]
    v_cvt_pk_bf16_f32 v108, v40, v41
    v_cvt_pk_bf16_f32 v109, v42, v43
    v_mfma_f32_16x16x32_bf16 v[60:63], v[36:39], a[172:175], v[16:19]
    v_cvt_pk_bf16_f32 v110, v44, v45
    v_cvt_pk_bf16_f32 v111, v46, v47
    s_waitcnt lgkmcnt(0)
    v_and_b32 v28, v12, v7
    v_and_b32 v29, v13, v8
    v_and_b32 v32, v14, v7
    v_and_b32 v33, v15, v8
    s_waitcnt vmcnt(9)
    v_mfma_f32_16x16x32_bf16 a[244:247], a[48:51], v[20:23], a[244:247]
    ds_read_b128 v[12:15], v9 offset:832
    ds_read_b128 v[24:27], v10 offset:832
    v_mfma_f32_16x16x32_bf16 v[40:43], v[28:31], a[48:51], 0
    v_cvt_pk_bf16_f32 v172, v48, v49
    v_cvt_pk_bf16_f32 v173, v50, v51
    v_mfma_f32_16x16x32_bf16 v[44:47], v[30:33], a[48:51], 0
    v_cvt_pk_bf16_f32 v174, v52, v53
    v_cvt_pk_bf16_f32 v175, v54, v55
    v_mfma_f32_16x16x32_bf16 a[248:251], a[112:115], v[20:23], a[248:251]
    v_mfma_f32_16x16x32_bf16 v[48:51], v[28:31], a[112:115], 0
    v_cvt_pk_bf16_f32 v236, v56, v57
    v_cvt_pk_bf16_f32 v237, v58, v59
    v_mfma_f32_16x16x32_bf16 v[52:55], v[30:33], a[112:115], 0
    v_cvt_pk_bf16_f32 v238, v60, v61
    v_cvt_pk_bf16_f32 v239, v62, v63
    s_cmp_lg_u32 s48, 0
    s_cbranch_scc1 L_p2_26
    s_mov_b32 s56, 40960
    buffer_load_dwordx4 v[252:255], v6, s[36:39], s56 offen sc1
L_p2_26:
    v_mfma_f32_16x16x32_bf16 a[252:255], a[176:179], v[20:23], a[252:255]
    v_mfma_f32_16x16x32_bf16 v[56:59], v[28:31], a[176:179], v[16:19]
    v_cvt_pk_bf16_f32 v112, v40, v41
    v_cvt_pk_bf16_f32 v113, v42, v43
    v_mfma_f32_16x16x32_bf16 v[60:63], v[30:33], a[176:179], v[16:19]
    v_cvt_pk_bf16_f32 v114, v44, v45
    v_cvt_pk_bf16_f32 v115, v46, v47
    s_waitcnt lgkmcnt(0)
    v_and_b32 v34, v12, v7
    v_and_b32 v35, v13, v8
    v_and_b32 v38, v14, v7
    v_and_b32 v39, v15, v8
    s_waitcnt vmcnt(6)
    v_mfma_f32_16x16x32_bf16 a[244:247], a[52:55], v[24:27], a[244:247]
    ds_read_b128 v[12:15], v9 offset:896
    ds_read_b128 v[20:23], v10 offset:896
    v_mfma_f32_16x16x32_bf16 v[40:43], v[34:37], a[52:55], 0
    v_cvt_pk_bf16_f32 v176, v48, v49
    v_cvt_pk_bf16_f32 v177, v50, v51
    v_mfma_f32_16x16x32_bf16 v[44:47], v[36:39], a[52:55], 0
    v_cvt_pk_bf16_f32 v178, v52, v53
    v_cvt_pk_bf16_f32 v179, v54, v55
    v_mfma_f32_16x16x32_bf16 a[248:251], a[116:119], v[24:27], a[248:251]
    v_mfma_f32_16x16x32_bf16 v[48:51], v[34:37], a[116:119], 0
    v_cvt_pk_bf16_f32 v240, v56, v57
    v_cvt_pk_bf16_f32 v241, v58, v59
    v_mfma_f32_16x16x32_bf16 v[52:55], v[36:39], a[116:119], 0
    v_cvt_pk_bf16_f32 v242, v60, v61
    v_cvt_pk_bf16_f32 v243, v62, v63
    v_mfma_f32_16x16x32_bf16 a[252:255], a[180:183], v[24:27], a[252:255]
    v_mfma_f32_16x16x32_bf16 v[56:59], v[34:37], a[180:183], v[16:19]
    v_cvt_pk_bf16_f32 v116, v40, v41
    v_cvt_pk_bf16_f32 v117, v42, v43
    v_mfma_f32_16x16x32_bf16 v[60:63], v[36:39], a[180:183], v[16:19]
    v_cvt_pk_bf16_f32 v118, v44, v45
    v_cvt_pk_bf16_f32 v119, v46, v47
    s_waitcnt lgkmcnt(0)
    v_and_b32 v28, v12, v7
    v_and_b32 v29, v13, v8
    v_and_b32 v32, v14, v7
    v_and_b32 v33, v15, v8
    s_waitcnt vmcnt(3)
    v_mfma_f32_16x16x32_bf16 a[244:247], a[56:59], v[20:23], a[244:247]
    ds_read_b128 v[12:15], v9 offset:960
    ds_read_b128 v[24:27], v10 offset:960
    v_mfma_f32_16x16x32_bf16 v[40:43], v[28:31], a[56:59], 0
    v_cvt_pk_bf16_f32 v180, v48, v49
    v_cvt_pk_bf16_f32 v181, v50, v51
    v_mfma_f32_16x16x32_bf16 v[44:47], v[30:33], a[56:59], 0
    v_cvt_pk_bf16_f32 v182, v52, v53
    v_cvt_pk_bf16_f32 v183, v54, v55
    v_mfma_f32_16x16x32_bf16 a[248:251], a[120:123], v[20:23], a[248:251]
    v_mfma_f32_16x16x32_bf16 v[48:51], v[28:31], a[120:123], 0
    v_cvt_pk_bf16_f32 v244, v56, v57
    v_cvt_pk_bf16_f32 v245, v58, v59
    v_mfma_f32_16x16x32_bf16 v[52:55], v[30:33], a[120:123], 0
    v_cvt_pk_bf16_f32 v246, v60, v61
    v_cvt_pk_bf16_f32 v247, v62, v63
    v_mfma_f32_16x16x32_bf16 a[252:255], a[184:187], v[20:23], a[252:255]
    v_mfma_f32_16x16x32_bf16 v[56:59], v[28:31], a[184:187], v[16:19]
    v_cvt_pk_bf16_f32 v120, v40, v41
    v_cvt_pk_bf16_f32 v121, v42, v43
    v_mfma_f32_16x16x32_bf16 v[60:63], v[30:33], a[184:187], v[16:19]
    v_cvt_pk_bf16_f32 v122, v44, v45
    v_cvt_pk_bf16_f32 v123, v46, v47
    s_waitcnt lgkmcnt(0)
    v_and_b32 v34, v12, v7
    v_and_b32 v35, v13, v8
    v_and_b32 v38, v14, v7
    v_and_b32 v39, v15, v8
    s_waitcnt vmcnt(0)
    v_mfma_f32_16x16x32_bf16 a[244:247], a[60:63], v[24:27], a[244:247]
    v_mfma_f32_16x16x32_bf16 v[40:43], v[34:37], a[60:63], 0
    v_cvt_pk_bf16_f32 v184, v48, v49
    v_cvt_pk_bf16_f32 v185, v50, v51
    v_mfma_f32_16x16x32_bf16 v[44:47], v[36:39], a[60:63], 0
    v_cvt_pk_bf16_f32 v186, v52, v53
    v_cvt_pk_bf16_f32 v187, v54, v55
    v_mfma_f32_16x16x32_bf16 a[248:251], a[124:127], v[24:27], a[248:251]
    v_mfma_f32_16x16x32_bf16 v[48:51], v[34:37], a[124:127], 0
    v_cvt_pk_bf16_f32 v248, v56, v57
    v_cvt_pk_bf16_f32 v249, v58, v59
    v_mfma_f32_16x16x32_bf16 v[52:55], v[36:39], a[124:127], 0
    v_cvt_pk_bf16_f32 v250, v60, v61
    v_cvt_pk_bf16_f32 v251, v62, v63
    s_cmp_lg_u32 s48, 0
    s_cbranch_scc1 L_back_28
    s_waitcnt vmcnt(0)
    v_xor_b32 v252, s52, v252
    v_xor_b32 v253, s52, v253
    v_xor_b32 v254, s52, v254
    v_xor_b32 v255, s52, v255
    v_or3_b32 v252, v252, v253, v254
    v_or_b32 v252, v252, v255
    v_cmp_ne_u32 vcc, 0, v252
    s_cbranch_vccnz L_slow_27
L_back_28:
    s_barrier
    v_mfma_f32_16x16x32_bf16 a[252:255], a[188:191], v[24:27], a[252:255]
    s_add_u32 m0, s81, 0
    s_add_u32 s56, s80, 0
    buffer_load_dwordx4 v188, s[36:39], s56 offen sc1 lds
    v_mfma_f32_16x16x32_bf16 v[56:59], v[34:37], a[188:191], v[16:19]
    v_cvt_pk_bf16_f32 v124, v40, v41
    v_cvt_pk_bf16_f32 v125, v42, v43
    v_mfma_f32_16x16x32_bf16 v[60:63], v[36:39], a[188:191], v[16:19]
    v_cvt_pk_bf16_f32 v126, v44, v45
    v_cvt_pk_bf16_f32 v127, v46, v47
    s_add_u32 m0, s81, 1024
    s_add_u32 s56, s80, 32768
    buffer_load_dwordx4 v189, s[36:39], s56 offen sc1 lds
    s_add_u32 m0, s81, 2048
    s_add_u32 s56, s80, 65536
    buffer_load_dwordx4 v188, s[36:39], s56 offen sc1 lds
    s_add_u32 m0, s81, 3072
    s_add_u32 s56, s80, 98304
    buffer_load_dwordx4 v189, s[36:39], s56 offen sc1 lds
    s_add_u32 m0, s81, 16384
    s_add_u32 s56, s80, 524288
    buffer_load_dwordx4 v188, s[36:39], s56 offen sc1 lds
    s_add_u32 m0, s81, 17408
    s_add_u32 s56, s80, 557056
    buffer_load_dwordx4 v189, s[36:39], s56 offen sc1 lds
    s_add_u32 m0, s81, 18432
    s_add_u32 s56, s80, 589824
    buffer_load_dwordx4 v188, s[36:39], s56 offen sc1 lds
    s_add_u32 m0, s81, 19456
    s_add_u32 s56, s80, 622592
    buffer_load_dwordx4 v189, s[36:39], s56 offen sc1 lds
    v_mov_b32 v9, v188
    v_mov_b32 v10, v189
    s_mul_i32 s54, s48, 384
    s_add_u32 s54, s54, 79872
    v_lshl_add_u32 v7, v3, 4, s54
    v_lshl_add_u32 v5, v2, 6, v7
    v_cvt_pk_bf16_f32 v188, v48, v49
    v_cvt_pk_bf16_f32 v189, v50, v51
    v_cvt_pk_bf16_f32 v190, v52, v53
    v_cvt_pk_bf16_f32 v191, v54, v55
    s_mov_b32 exec_lo, 0x00030003
    s_mov_b32 exec_hi, 0x00030003
    ds_write_b128 v5, a[244:247] offset:0
    ds_write_b128 v5, a[248:251] offset:128
    ds_write_b128 v5, a[252:255] offset:256
    s_mov_b64 exec, -1
    v_cvt_pk_bf16_f32 v252, v56, v57
    v_cvt_pk_bf16_f32 v253, v58, v59
    v_cvt_pk_bf16_f32 v254, v60, v61
    v_cvt_pk_bf16_f32 v255, v62, v63
    v_lshrrev_b32 v4, 2, v2
    v_lshl_add_u32 v5, v3, 3, v4
    v_lshlrev_b32 v5, 7, v5
    v_and_b32 v8, 3, v2
    v_lshl_add_u32 v5, v8, 3, v5
    v_lshrrev_b32 v4, 1, v4
    v_and_b32 v8, 1, v3
    v_lshl_add_u32 v4, v8, 1, v4
    v_xor_b32 v4, s71, v4
    v_lshl_add_u32 v8, v4, 5, v5
    v_xor_b32 v11, 32, v8
    s_add_u32 s20, s8, s40
    s_add_u32 s21, s9, s40
    s_add_u32 s22, s10, s40
    s_add_u32 s23, s11, s40
    v_and_b32 v4, 3, v2
    v_cmp_eq_u32 s[64:65], 1, v4
    v_cmp_eq_u32 s[66:67], 2, v4
    v_cmp_eq_u32 s[68:69], 3, v4
    s_mul_i32 s54, s73, 3
    s_add_u32 s54, s54, s48
    s_cmp_lt_u32 s54, 22
    s_cselect_b32 s55, s48, 3
    s_lshl_b32 s57, s54, 9
    s_add_u32 s57, s57, 32768
    s_cmp_lt_u32 s55, 3
    s_cselect_b32 s57, s57, 0x7f000000
    s_lshl_b32 s58, s72, 3
    s_add_u32 s58, s58, s73
    s_lshl_b32 s58, s58, 7
    s_lshl_b32 s54, s48, 2
    s_add_u32 s58, s58, s54
    s_add_u32 s58, s58, 65536
    s_cmp_eq_u32 s45, 0
    s_cselect_b32 s28, s58, 0x7f000000
    s_cselect_b32 s58, 0x7f000000, s58
    s_mov_b32 s62, 0x3b000000
    ds_read_b128 v[40:43], v7 offset:0
    ds_read_b128 v[44:47], v7 offset:64
    ds_read_b128 v[48:51], v7 offset:128
    ds_read_b128 v[52:55], v7 offset:192
    ds_read_b128 v[56:59], v7 offset:256
    ds_read_b128 v[60:63], v7 offset:320
    s_lshl_b32 s60, s72, 10
    s_add_u32 s60, s60, 65536
    s_mul_i32 s24, s53, 11264
    s_add_u32 s24, s24, 10485760
    s_cmp_eq_u32 s53, 3
    s_cselect_b32 s25, 0x7f000000, 0
    s_waitcnt vmcnt(4)
    s_barrier
    ds_read_b64_tr_b16 a[192:193], v8 offset:0
    ds_read_b64_tr_b16 a[194:195], v8 offset:512
    ds_read_b64_tr_b16 a[196:197], v11 offset:0
    ds_read_b64_tr_b16 a[198:199], v11 offset:512
    s_waitcnt lgkmcnt(2)
    v_mfma_f32_16x16x32_bf16 a[208:211], a[192:195], a[192:195], 0
    ds_read_b64_tr_b16 a[200:201], v8 offset:4096
    v_mfma_f32_16x16x32_bf16 v[16:19], v[64:67], a[192:195], 0
    ds_read_b64_tr_b16 a[202:203], v8 offset:4608
    v_mfma_f32_16x16x32_bf16 v[20:23], v[128:131], a[192:195], 0
    ds_read_b64_tr_b16 a[204:205], v11 offset:4096
    v_mfma_f32_16x16x32_bf16 v[32:35], v[192:195], a[192:195], 0
    ds_read_b64_tr_b16 a[206:207], v11 offset:4608
    s_waitcnt lgkmcnt(4)
    v_mfma_f32_16x16x32_bf16 v[24:27], v[64:67], a[196:199], 0
    s_add_u32 m0, s81, 32768
    s_add_u32 s56, s80, 1048576
    buffer_load_dwordx4 v9, s[36:39], s56 offen sc1 lds
    v_mfma_f32_16x16x32_bf16 v[28:31], v[128:131], a[196:199], 0
    s_add_u32 m0, s81, 33792
    s_add_u32 s56, s80, 1081344
    buffer_load_dwordx4 v10, s[36:39], s56 offen sc1 lds
    v_mfma_f32_16x16x32_bf16 v[36:39], v[192:195], a[196:199], 0
    s_waitcnt lgkmcnt(2)
    v_mfma_f32_16x16x32_bf16 a[208:211], a[200:203], a[200:203], a[208:211]
    ds_read_b64_tr_b16 a[192:193], v8 offset:8192
    v_mfma_f32_16x16x32_bf16 v[16:19], v[68:71], a[200:203], v[16:19]
    ds_read_b64_tr_b16 a[194:195], v8 offset:8704
    v_mfma_f32_16x16x32_bf16 v[20:23], v[132:135], a[200:203], v[20:23]
    ds_read_b64_tr_b16 a[196:197], v11 offset:8192
    v_mfma_f32_16x16x32_bf16 v[32:35], v[196:199], a[200:203], v[32:35]
    ds_read_b64_tr_b16 a[198:199], v11 offset:8704
    s_waitcnt lgkmcnt(4)
    v_mfma_f32_16x16x32_bf16 v[24:27], v[68:71], a[204:207], v[24:27]
    s_add_u32 m0, s81, 34816
    s_add_u32 s56, s80, 1114112
    buffer_load_dwordx4 v9, s[36:39], s56 offen sc1 lds
    v_mfma_f32_16x16x32_bf16 v[28:31], v[132:135], a[204:207], v[28:31]
    s_add_u32 m0, s81, 35840
    s_add_u32 s56, s80, 1146880
    buffer_load_dwordx4 v10, s[36:39], s56 offen sc1 lds
    v_mfma_f32_16x16x32_bf16 v[36:39], v[196:199], a[204:207], v[36:39]
    s_waitcnt lgkmcnt(2)
    v_mfma_f32_16x16x32_bf16 a[208:211], a[192:195], a[192:195], a[208:211]
    ds_read_b64_tr_b16 a[200:201], v8 offset:12288
    v_mfma_f32_16x16x32_bf16 v[16:19], v[72:75], a[192:195], v[16:19]
    ds_read_b64_tr_b16 a[202:203], v8 offset:12800
    v_mfma_f32_16x16x32_bf16 v[20:23], v[136:139], a[192:195], v[20:23]
    ds_read_b64_tr_b16 a[204:205], v11 offset:12288
    v_mfma_f32_16x16x32_bf16 v[32:35], v[200:203], a[192:195], v[32:35]
    ds_read_b64_tr_b16 a[206:207], v11 offset:12800
    s_waitcnt lgkmcnt(4)
    v_mfma_f32_16x16x32_bf16 v[24:27], v[72:75], a[196:199], v[24:27]
    s_add_u32 m0, s81, 49152
    s_add_u32 s56, s80, 1572864
    buffer_load_dwordx4 v9, s[36:39], s56 offen sc1 lds
    v_mfma_f32_16x16x32_bf16 v[28:31], v[136:139], a[196:199], v[28:31]
    s_add_u32 m0, s81, 50176
    s_add_u32 s56, s80, 1605632
    buffer_load_dwordx4 v10, s[36:39], s56 offen sc1 lds
    v_mfma_f32_16x16x32_bf16 v[36:39], v[200:203], a[196:199], v[36:39]
    s_waitcnt vmcnt(6)
    s_barrier
    s_waitcnt lgkmcnt(2)
    v_mfma_f32_16x16x32_bf16 a[208:211], a[200:203], a[200:203], a[208:211]
    ds_read_b64_tr_b16 a[192:193], v8 offset:16384
    v_mfma_f32_16x16x32_bf16 v[16:19], v[76:79], a[200:203], v[16:19]
    ds_read_b64_tr_b16 a[194:195], v8 offset:16896
    v_mfma_f32_16x16x32_bf16 v[20:23], v[140:143], a[200:203], v[20:23]
    ds_read_b64_tr_b16 a[196:197], v11 offset:16384
    v_mfma_f32_16x16x32_bf16 v[32:35], v[204:207], a[200:203], v[32:35]
    ds_read_b64_tr_b16 a[198:199], v11 offset:16896
    s_waitcnt lgkmcnt(4)
    v_mfma_f32_16x16x32_bf16 v[24:27], v[76:79], a[204:207], v[24:27]
    s_add_u32 m0, s81, 51200
    s_add_u32 s56, s80, 1638400
    buffer_load_dwordx4 v9, s[36:39], s56 offen sc1 lds
    v_mfma_f32_16x16x32_bf16 v[28:31], v[140:143], a[204:207], v[28:31]
    s_add_u32 m0, s81, 52224
    s_add_u32 s56, s80, 1671168
    buffer_load_dwordx4 v10, s[36:39], s56 offen sc1 lds
    v_mfma_f32_16x16x32_bf16 v[36:39], v[204:207], a[204:207], v[36:39]
    s_waitcnt lgkmcnt(2)
    v_mfma_f32_16x16x32_bf16 a[208:211], a[192:195], a[192:195], a[208:211]
    ds_read_b64_tr_b16 a[200:201], v8 offset:20480
    v_mfma_f32_16x16x32_bf16 v[16:19], v[80:83], a[192:195], v[16:19]
    ds_read_b64_tr_b16 a[202:203], v8 offset:20992
    buffer_load_dwordx4 a[0:3], v6, s[36:39], s7 offen offset:0 sc1
    v_mfma_f32_16x16x32_bf16 v[20:23], v[144:147], a[192:195], v[20:23]
    ds_read_b64_tr_b16 a[204:205], v11 offset:20480
    v_mfma_f32_16x16x32_bf16 v[32:35], v[208:211], a[192:195], v[32:35]
    ds_read_b64_tr_b16 a[206:207], v11 offset:20992
    s_waitcnt lgkmcnt(4)
    v_mfma_f32_16x16x32_bf16 v[24:27], v[80:83], a[196:199], v[24:27]
    v_mfma_f32_16x16x32_bf16 v[28:31], v[144:147], a[196:199], v[28:31]
    v_mfma_f32_16x16x32_bf16 v[36:39], v[208:211], a[196:199], v[36:39]
    buffer_load_dwordx4 a[64:67], v6, s[36:39], s7 offen offset:1024 sc1
    s_add_u32 s7, s7, 4096
    s_waitcnt lgkmcnt(2)
    v_mfma_f32_16x16x32_bf16 a[208:211], a[200:203], a[200:203], a[208:211]
    ds_read_b64_tr_b16 a[192:193], v8 offset:24576
    v_mfma_f32_16x16x32_bf16 v[16:19], v[84:87], a[200:203], v[16:19]
    ds_read_b64_tr_b16 a[194:195], v8 offset:25088
    v_mfma_f32_16x16x32_bf16 v[20:23], v[148:151], a[200:203], v[20:23]
    ds_read_b64_tr_b16 a[196:197], v11 offset:24576
    v_mfma_f32_16x16x32_bf16 v[32:35], v[212:215], a[200:203], v[32:35]
    ds_read_b64_tr_b16 a[198:199], v11 offset:25088
    s_waitcnt lgkmcnt(4)
    v_mfma_f32_16x16x32_bf16 v[24:27], v[84:87], a[204:207], v[24:27]
    buffer_load_dwordx4 a[128:131], v6, s[36:39], s12 offen offset:0 sc1
    v_mfma_f32_16x16x32_bf16 v[28:31], v[148:151], a[204:207], v[28:31]
    v_mfma_f32_16x16x32_bf16 v[36:39], v[212:215], a[204:207], v[36:39]
    s_waitcnt lgkmcnt(2)
    v_mfma_f32_16x16x32_bf16 a[208:211], a[192:195], a[192:195], a[208:211]
    ds_read_b64_tr_b16 a[200:201], v8 offset:28672
    v_mfma_f32_16x16x32_bf16 v[16:19], v[88:91], a[192:195], v[16:19]
    ds_read_b64_tr_b16 a[202:203], v8 offset:29184
    v_mfma_f32_16x16x32_bf16 v[20:23], v[152:155], a[192:195], v[20:23]
    ds_read_b64_tr_b16 a[204:205], v11 offset:28672
    buffer_load_dwordx4 a[4:7], v6, s[36:39], s12 offen offset:1024 sc1
    s_add_u32 s12, s12, 4096
    v_mfma_f32_16x16x32_bf16 v[32:35], v[216:219], a[192:195], v[32:35]
    ds_read_b64_tr_b16 a[206:207], v11 offset:29184
    s_waitcnt lgkmcnt(4)
    v_mfma_f32_16x16x32_bf16 v[24:27], v[88:91], a[196:199], v[24:27]
    v_mfma_f32_16x16x32_bf16 v[28:31], v[152:155], a[196:199], v[28:31]
    v_mfma_f32_16x16x32_bf16 v[36:39], v[216:219], a[196:199], v[36:39]
    s_waitcnt vmcnt(8)
    s_barrier
    s_waitcnt lgkmcnt(2)
    v_mfma_f32_16x16x32_bf16 a[208:211], a[200:203], a[200:203], a[208:211]
    ds_read_b64_tr_b16 a[192:193], v8 offset:32768
    buffer_load_dwordx4 a[68:71], v6, s[36:39], s7 offen offset:0 sc1
    v_mfma_f32_16x16x32_bf16 v[16:19], v[92:95], a[200:203], v[16:19]
    ds_read_b64_tr_b16 a[194:195], v8 offset:33280
    v_mfma_f32_16x16x32_bf16 v[20:23], v[156:159], a[200:203], v[20:23]
    ds_read_b64_tr_b16 a[196:197], v11 offset:32768
    v_mfma_f32_16x16x32_bf16 v[32:35], v[220:223], a[200:203], v[32:35]
    ds_read_b64_tr_b16 a[198:199], v11 offset:33280
    s_waitcnt lgkmcnt(4)
    v_mfma_f32_16x16x32_bf16 v[24:27], v[92:95], a[204:207], v[24:27]
    v_mfma_f32_16x16x32_bf16 v[28:31], v[156:159], a[204:207], v[28:31]
    buffer_load_dwordx4 a[132:135], v6, s[36:39], s7 offen offset:1024 sc1
    s_add_u32 s7, s7, 4096
    v_mfma_f32_16x16x32_bf16 v[36:39], v[220:223], a[204:207], v[36:39]
    s_waitcnt lgkmcnt(2)
    v_mfma_f32_16x16x32_bf16 a[208:211], a[192:195], a[192:195], a[208:211]
    ds_read_b64_tr_b16 a[200:201], v8 offset:36864
    v_mfma_f32_16x16x32_bf16 v[16:19], v[96:99], a[192:195], v[16:19]
    ds_read_b64_tr_b16 a[202:203], v8 offset:37376
    v_mfma_f32_16x16x32_bf16 v[20:23], v[160:163], a[192:195], v[20:23]
    ds_read_b64_tr_b16 a[204:205], v11 offset:36864
    v_mfma_f32_16x16x32_bf16 v[32:35], v[224:227], a[192:195], v[32:35]
    ds_read_b64_tr_b16 a[206:207], v11 offset:37376
    buffer_load_dwordx4 a[8:11], v6, s[36:39], s12 offen offset:0 sc1
    s_waitcnt lgkmcnt(4)
    v_mfma_f32_16x16x32_bf16 v[24:27], v[96:99], a[196:199], v[24:27]
    v_mfma_f32_16x16x32_bf16 v[28:31], v[160:163], a[196:199], v[28:31]
    v_mfma_f32_16x16x32_bf16 v[36:39], v[224:227], a[196:199], v[36:39]
    s_waitcnt lgkmcnt(2)
    v_mfma_f32_16x16x32_bf16 a[208:211], a[200:203], a[200:203], a[208:211]
    ds_read_b64_tr_b16 a[192:193], v8 offset:40960
    v_mfma_f32_16x16x32_bf16 v[16:19], v[100:103], a[200:203], v[16:19]
    ds_read_b64_tr_b16 a[194:195], v8 offset:41472
    buffer_load_dwordx4 a[72:75], v6, s[36:39], s12 offen offset:1024 sc1
    s_add_u32 s12, s12, 4096
    v_mfma_f32_16x16x32_bf16 v[20:23], v[164:167], a[200:203], v[20:23]
    ds_read_b64_tr_b16 a[196:197], v11 offset:40960
    v_mfma_f32_16x16x32_bf16 v[32:35], v[228:231], a[200:203], v[32:35]
    ds_read_b64_tr_b16 a[198:199], v11 offset:41472
    s_waitcnt lgkmcnt(4)
    v_mfma_f32_16x16x32_bf16 v[24:27], v[100:103], a[204:207], v[24:27]
    v_mfma_f32_16x16x32_bf16 v[28:31], v[164:167], a[204:207], v[28:31]
    v_mfma_f32_16x16x32_bf16 v[36:39], v[228:231], a[204:207], v[36:39]
    buffer_load_dwordx4 a[136:139], v6, s[36:39], s7 offen offset:0 sc1
    s_waitcnt lgkmcnt(2)
    v_mfma_f32_16x16x32_bf16 a[208:211], a[192:195], a[192:195], a[208:211]
    ds_read_b64_tr_b16 a[200:201], v8 offset:45056
    v_mfma_f32_16x16x32_bf16 v[16:19], v[104:107], a[192:195], v[16:19]
    ds_read_b64_tr_b16 a[202:203], v8 offset:45568
    v_mfma_f32_16x16x32_bf16 v[20:23], v[168:171], a[192:195], v[20:23]
    ds_read_b64_tr_b16 a[204:205], v11 offset:45056
    v_mfma_f32_16x16x32_bf16 v[32:35], v[232:235], a[192:195], v[32:35]
    ds_read_b64_tr_b16 a[206:207], v11 offset:45568
    s_waitcnt lgkmcnt(4)
    v_mfma_f32_16x16x32_bf16 v[24:27], v[104:107], a[196:199], v[24:27]
    buffer_load_dwordx4 a[12:15], v6, s[36:39], s7 offen offset:1024 sc1
    s_add_u32 s7, s7, 4096
    v_mfma_f32_16x16x32_bf16 v[28:31], v[168:171], a[196:199], v[28:31]
    v_mfma_f32_16x16x32_bf16 v[36:39], v[232:235], a[196:199], v[36:39]
    s_waitcnt vmcnt(10)
    s_barrier
    s_waitcnt lgkmcnt(2)
    v_mfma_f32_16x16x32_bf16 a[208:211], a[200:203], a[200:203], a[208:211]
    ds_read_b64_tr_b16 a[192:193], v8 offset:49152
    v_mfma_f32_16x16x32_bf16 v[16:19], v[108:111], a[200:203], v[16:19]
    ds_read_b64_tr_b16 a[194:195], v8 offset:49664
    v_mfma_f32_16x16x32_bf16 v[20:23], v[172:175], a[200:203], v[20:23]
    ds_read_b64_tr_b16 a[196:197], v11 offset:49152
    buffer_load_dwordx4 a[76:79], v6, s[36:39], s12 offen offset:0 sc1
    v_mfma_f32_16x16x32_bf16 v[32:35], v[236:239], a[200:203], v[32:35]
    ds_read_b64_tr_b16 a[198:199], v11 offset:49664
    s_waitcnt lgkmcnt(4)
    v_mfma_f32_16x16x32_bf16 v[24:27], v[108:111], a[204:207], v[24:27]
    v_mfma_f32_16x16x32_bf16 v[28:31], v[172:175], a[204:207], v[28:31]
    v_mfma_f32_16x16x32_bf16 v[36:39], v[236:239], a[204:207], v[36:39]
    s_waitcnt lgkmcnt(2)
    v_mfma_f32_16x16x32_bf16 a[208:211], a[192:195], a[192:195], a[208:211]
    ds_read_b64_tr_b16 a[200:201], v8 offset:53248
    buffer_load_dwordx4 a[140:143], v6, s[36:39], s12 offen offset:1024 sc1
    s_add_u32 s12, s12, 4096
    v_mfma_f32_16x16x32_bf16 v[16:19], v[112:115], a[192:195], v[16:19]
    ds_read_b64_tr_b16 a[202:203], v8 offset:53760
    v_mfma_f32_16x16x32_bf16 v[20:23], v[176:179], a[192:195], v[20:23]
    ds_read_b64_tr_b16 a[204:205], v11 offset:53248
    v_mfma_f32_16x16x32_bf16 v[32:35], v[240:243], a[192:195], v[32:35]
    ds_read_b64_tr_b16 a[206:207], v11 offset:53760
    s_waitcnt lgkmcnt(4)
    v_mfma_f32_16x16x32_bf16 v[24:27], v[112:115], a[196:199], v[24:27]
    v_mfma_f32_16x16x32_bf16 v[28:31], v[176:179], a[196:199], v[28:31]
    buffer_load_dwordx4 a[16:19], v6, s[36:39], s7 offen offset:0 sc1
    v_mfma_f32_16x16x32_bf16 v[36:39], v[240:243], a[196:199], v[36:39]
    s_waitcnt lgkmcnt(2)
    v_mfma_f32_16x16x32_bf16 a[208:211], a[200:203], a[200:203], a[208:211]
    ds_read_b64_tr_b16 a[192:193], v8 offset:57344
    v_mfma_f32_16x16x32_bf16 v[16:19], v[116:119], a[200:203], v[16:19]
    ds_read_b64_tr_b16 a[194:195], v8 offset:57856
    v_mfma_f32_16x16x32_bf16 v[20:23], v[180:183], a[200:203], v[20:23]
    ds_read_b64_tr_b16 a[196:197], v11 offset:57344
    v_mfma_f32_16x16x32_bf16 v[32:35], v[244:247], a[200:203], v[32:35]
    ds_read_b64_tr_b16 a[198:199], v11 offset:57856
    buffer_load_dwordx4 a[80:83], v6, s[36:39], s7 offen offset:1024 sc1
    s_add_u32 s7, s7, 4096
    s_waitcnt lgkmcnt(4)
    v_mfma_f32_16x16x32_bf16 v[24:27], v[116:119], a[204:207], v[24:27]
    v_mfma_f32_16x16x32_bf16 v[28:31], v[180:183], a[204:207], v[28:31]
    v_mfma_f32_16x16x32_bf16 v[36:39], v[244:247], a[204:207], v[36:39]
    s_waitcnt lgkmcnt(2)
    v_mfma_f32_16x16x32_bf16 a[208:211], a[192:195], a[192:195], a[208:211]
    ds_read_b64_tr_b16 a[200:201], v8 offset:61440
    v_mfma_f32_16x16x32_bf16 v[16:19], v[120:123], a[192:195], v[16:19]
    ds_read_b64_tr_b16 a[202:203], v8 offset:61952
    buffer_load_dwordx4 a[144:147], v6, s[36:39], s12 offen offset:0 sc1
    v_mfma_f32_16x16x32_bf16 v[20:23], v[184:187], a[192:195], v[20:23]
    ds_read_b64_tr_b16 a[204:205], v11 offset:61440
    v_mfma_f32_16x16x32_bf16 v[32:35], v[248:251], a[192:195], v[32:35]
    ds_read_b64_tr_b16 a[206:207], v11 offset:61952
    s_waitcnt lgkmcnt(4)
    v_mfma_f32_16x16x32_bf16 v[24:27], v[120:123], a[196:199], v[24:27]
    v_mfma_f32_16x16x32_bf16 v[28:31], v[184:187], a[196:199], v[28:31]
    v_mfma_f32_16x16x32_bf16 v[36:39], v[248:251], a[196:199], v[36:39]
    buffer_load_dwordx4 a[20:23], v6, s[36:39], s12 offen offset:1024 sc1
    s_add_u32 s12, s12, 4096
    s_waitcnt lgkmcnt(2)
    v_mfma_f32_16x16x32_bf16 a[208:211], a[200:203], a[200:203], a[208:211]
    v_lshlrev_b32 v7, 3, v2
    v_add_u32 v7, 81408, v7
    v_mfma_f32_16x16x32_bf16 v[32:35], v[252:255], a[200:203], v[32:35]
    v_and_b32 v9, 0x1ff, v6
    v_add_u32 v9, s57, v9
    s_waitcnt lgkmcnt(0)
    v_mfma_f32_16x16x32_bf16 v[36:39], v[252:255], a[204:207], v[36:39]
    v_add_u32 v4, s16, v7
    v_add_u32 v5, s17, v7
    v_mfma_f32_16x16x32_bf16 v[16:19], v[124:127], a[200:203], v[16:19]
    v_xor_b32 v8, 64, v8
    v_xor_b32 v11, 64, v11
    v_mfma_f32_16x16x32_bf16 v[20:23], v[188:191], a[200:203], v[20:23]
    v_mfma_f32_16x16x32_bf16 v[24:27], v[124:127], a[204:207], v[24:27]
    v_mfma_f32_16x16x32_bf16 v[28:31], v[188:191], a[204:207], v[28:31]
    v_accvgpr_read_b32 v12, a208
    v_accvgpr_read_b32 v13, a209
    v_accvgpr_read_b32 v14, a210
    v_accvgpr_read_b32 v15, a211
    ds_read_b64_tr_b16 a[192:193], v8 offset:0
    ds_read_b64_tr_b16 a[194:195], v8 offset:512
    ds_read_b64_tr_b16 a[196:197], v11 offset:0
    ds_read_b64_tr_b16 a[198:199], v11 offset:512
    v_cndmask_b32 v12, v12, v13, s[64:65]
    v_cndmask_b32 v12, v12, v14, s[66:67]
    v_cndmask_b32 v12, v12, v15, s[68:69]
    s_mov_b32 exec_lo, 0x00f0000f
    s_mov_b32 exec_hi, 0xf0000f00
    ds_write_b32 v4, v12 offset:4
    s_mov_b64 exec, -1
    s_cmp_lg_u32 s48, 3
    s_cbranch_scc1 L_sum_29
    ds_write_b32 v4, v32
    ds_write_b32 v5, v36
L_sum_29:
    buffer_load_dwordx4 a[84:87], v6, s[36:39], s7 offen offset:0 sc1
    buffer_load_dwordx4 a[148:151], v6, s[36:39], s7 offen offset:1024 sc1
    s_add_u32 s7, s7, 4096
    buffer_load_dwordx4 a[24:27], v6, s[36:39], s12 offen offset:0 sc1
    buffer_load_dwordx4 a[88:91], v6, s[36:39], s12 offen offset:1024 sc1
    s_add_u32 s12, s12, 4096
    s_waitcnt lgkmcnt(0)
    s_barrier
    ds_read_b64 v[12:13], v4
    ds_read_b64 v[14:15], v5
    v_mov_b32 v4, s8
    v_mov_b32 v5, s9
    v_cmp_gt_u32 vcc, 32, v1
    s_nop 1
    v_cndmask_b32 v4, v5, v4, vcc
    v_add_u32 v4, v4, v9
    s_waitcnt lgkmcnt(0)
    v_pk_mul_f32 v[12:13], v[12:13], s[62:63] op_sel_hi:[1,0]
    v_pk_mul_f32 v[14:15], v[14:15], s[62:63] op_sel_hi:[1,0]
    v_fma_f32 v13, -v12, v12, v13
    v_fma_f32 v15, -v14, v14, v15
    v_max_f32 v13, 0, v13
    v_max_f32 v15, 0, v15
    v_add_f32 v13, 0x3727c5ac, v13
    v_add_f32 v15, 0x3727c5ac, v15
    v_rsq_f32 v13, v13
    v_rsq_f32 v15, v15
    v_pk_fma_f32 v[16:17], v[40:41], v[12:13], v[16:17] op_sel_hi:[1,0,1] neg_lo:[0,1,0] neg_hi:[0,1,0]
    v_pk_fma_f32 v[18:19], v[42:43], v[12:13], v[18:19] op_sel_hi:[1,0,1] neg_lo:[0,1,0] neg_hi:[0,1,0]
    v_pk_fma_f32 v[16:17], v[16:17], v[12:13], v[44:45] op_sel:[0,1,0] op_sel_hi:[1,1,1]
    v_pk_fma_f32 v[18:19], v[18:19], v[12:13], v[46:47] op_sel:[0,1,0] op_sel_hi:[1,1,1]
    v_pk_fma_f32 v[20:21], v[48:49], v[12:13], v[20:21] op_sel_hi:[1,0,1] neg_lo:[0,1,0] neg_hi:[0,1,0]
    v_pk_fma_f32 v[22:23], v[50:51], v[12:13], v[22:23] op_sel_hi:[1,0,1] neg_lo:[0,1,0] neg_hi:[0,1,0]
    v_pk_fma_f32 v[20:21], v[20:21], v[12:13], v[52:53] op_sel:[0,1,0] op_sel_hi:[1,1,1]
    v_pk_fma_f32 v[22:23], v[22:23], v[12:13], v[54:55] op_sel:[0,1,0] op_sel_hi:[1,1,1]
    v_cvt_pk_bf16_f32 v16, v16, v17
    v_cvt_pk_bf16_f32 v17, v18, v19
    v_cvt_pk_bf16_f32 v18, v20, v21
    v_cvt_pk_bf16_f32 v19, v22, v23
    v_pk_max_i16 v16, v16, 0
    v_pk_max_i16 v17, v17, 0
    v_pk_max_i16 v18, v18, 0
    v_pk_max_i16 v19, v19, 0
    buffer_store_dwordx4 v[16:19], v6, s[36:39], s20 offen sc1
    v_pk_fma_f32 v[24:25], v[40:41], v[14:15], v[24:25] op_sel_hi:[1,0,1] neg_lo:[0,1,0] neg_hi:[0,1,0]
    v_pk_fma_f32 v[26:27], v[42:43], v[14:15], v[26:27] op_sel_hi:[1,0,1] neg_lo:[0,1,0] neg_hi:[0,1,0]
    v_pk_fma_f32 v[24:25], v[24:25], v[14:15], v[44:45] op_sel:[0,1,0] op_sel_hi:[1,1,1]
    v_pk_fma_f32 v[26:27], v[26:27], v[14:15], v[46:47] op_sel:[0,1,0] op_sel_hi:[1,1,1]
    v_pk_fma_f32 v[28:29], v[48:49], v[14:15], v[28:29] op_sel_hi:[1,0,1] neg_lo:[0,1,0] neg_hi:[0,1,0]
    v_pk_fma_f32 v[30:31], v[50:51], v[14:15], v[30:31] op_sel_hi:[1,0,1] neg_lo:[0,1,0] neg_hi:[0,1,0]
    v_pk_fma_f32 v[28:29], v[28:29], v[14:15], v[52:53] op_sel:[0,1,0] op_sel_hi:[1,1,1]
    v_pk_fma_f32 v[30:31], v[30:31], v[14:15], v[54:55] op_sel:[0,1,0] op_sel_hi:[1,1,1]
    v_cvt_pk_bf16_f32 v24, v24, v25
    v_cvt_pk_bf16_f32 v25, v26, v27
    v_cvt_pk_bf16_f32 v26, v28, v29
    v_cvt_pk_bf16_f32 v27, v30, v31
    v_pk_max_i16 v24, v24, 0
    v_pk_max_i16 v25, v25, 0
    v_pk_max_i16 v26, v26, 0
    v_pk_max_i16 v27, v27, 0
    buffer_store_dwordx4 v[24:27], v6, s[36:39], s21 offen sc1
    v_pk_fma_f32 v[32:33], v[56:57], v[12:13], v[32:33] op_sel_hi:[1,0,1] neg_lo:[0,1,0] neg_hi:[0,1,0]
    v_pk_fma_f32 v[34:35], v[58:59], v[12:13], v[34:35] op_sel_hi:[1,0,1] neg_lo:[0,1,0] neg_hi:[0,1,0]
    v_pk_fma_f32 v[32:33], v[32:33], v[12:13], v[60:61] op_sel:[0,1,0] op_sel_hi:[1,1,1]
    v_pk_fma_f32 v[34:35], v[34:35], v[12:13], v[62:63] op_sel:[0,1,0] op_sel_hi:[1,1,1]
    v_pk_fma_f32 v[36:37], v[56:57], v[14:15], v[36:37] op_sel_hi:[1,0,1] neg_lo:[0,1,0] neg_hi:[0,1,0]
    v_pk_fma_f32 v[38:39], v[58:59], v[14:15], v[38:39] op_sel_hi:[1,0,1] neg_lo:[0,1,0] neg_hi:[0,1,0]
    v_pk_fma_f32 v[36:37], v[36:37], v[14:15], v[60:61] op_sel:[0,1,0] op_sel_hi:[1,1,1]
    v_pk_fma_f32 v[38:39], v[38:39], v[14:15], v[62:63] op_sel:[0,1,0] op_sel_hi:[1,1,1]
    v_cvt_pk_bf16_f32 v32, v32, v33
    v_cvt_pk_bf16_f32 v33, v34, v35
    v_cvt_pk_bf16_f32 v34, v36, v37
    v_cvt_pk_bf16_f32 v35, v38, v39
    v_pk_max_i16 v32, v32, 0
    v_pk_max_i16 v33, v33, 0
    v_pk_max_i16 v34, v34, 0
    v_pk_max_i16 v35, v35, 0
    s_nop 0
    v_permlane32_swap_b32 v32, v34
    v_permlane32_swap_b32 v33, v35
    buffer_store_dwordx4 v[32:35], v4, s[36:39], 0 offen sc1
    v_and_b32 v10, 7, v1
    v_lshlrev_b32 v10, 7, v10
    v_mfma_f32_16x16x32_bf16 a[208:211], a[192:195], a[192:195], 0
    ds_read_b64_tr_b16 a[200:201], v8 offset:4096
    v_mfma_f32_16x16x32_bf16 v[16:19], v[64:67], a[192:195], 0
    ds_read_b64_tr_b16 a[202:203], v8 offset:4608
    v_mfma_f32_16x16x32_bf16 v[20:23], v[128:131], a[192:195], 0
    ds_read_b64_tr_b16 a[204:205], v11 offset:4096
    buffer_load_dwordx4 a[152:155], v6, s[36:39], s7 offen offset:0 sc1
    v_mfma_f32_16x16x32_bf16 v[32:35], v[192:195], a[192:195], 0
    ds_read_b64_tr_b16 a[206:207], v11 offset:4608
    v_mfma_f32_16x16x32_bf16 v[24:27], v[64:67], a[196:199], 0
    v_mfma_f32_16x16x32_bf16 v[28:31], v[128:131], a[196:199], 0
    v_mfma_f32_16x16x32_bf16 v[36:39], v[192:195], a[196:199], 0
    s_waitcnt lgkmcnt(2)
    v_mfma_f32_16x16x32_bf16 a[208:211], a[200:203], a[200:203], a[208:211]
    ds_read_b64_tr_b16 a[192:193], v8 offset:8192
    buffer_load_dwordx4 a[28:31], v6, s[36:39], s7 offen offset:1024 sc1
    s_add_u32 s7, s7, 4096
    v_mfma_f32_16x16x32_bf16 v[16:19], v[68:71], a[200:203], v[16:19]
    ds_read_b64_tr_b16 a[194:195], v8 offset:8704
    v_mfma_f32_16x16x32_bf16 v[20:23], v[132:135], a[200:203], v[20:23]
    ds_read_b64_tr_b16 a[196:197], v11 offset:8192
    v_mfma_f32_16x16x32_bf16 v[32:35], v[196:199], a[200:203], v[32:35]
    ds_read_b64_tr_b16 a[198:199], v11 offset:8704
    s_waitcnt lgkmcnt(4)
    v_mfma_f32_16x16x32_bf16 v[24:27], v[68:71], a[204:207], v[24:27]
    v_mfma_f32_16x16x32_bf16 v[28:31], v[132:135], a[204:207], v[28:31]
    buffer_load_dwordx4 a[92:95], v6, s[36:39], s12 offen offset:0 sc1
    v_mfma_f32_16x16x32_bf16 v[36:39], v[196:199], a[204:207], v[36:39]
    s_waitcnt lgkmcnt(2)
    v_mfma_f32_16x16x32_bf16 a[208:211], a[192:195], a[192:195], a[208:211]
    ds_read_b64_tr_b16 a[200:201], v8 offset:12288
    v_mfma_f32_16x16x32_bf16 v[16:19], v[72:75], a[192:195], v[16:19]
    ds_read_b64_tr_b16 a[202:203], v8 offset:12800
    v_mfma_f32_16x16x32_bf16 v[20:23], v[136:139], a[192:195], v[20:23]
    ds_read_b64_tr_b16 a[204:205], v11 offset:12288
    v_mfma_f32_16x16x32_bf16 v[32:35], v[200:203], a[192:195], v[32:35]
    ds_read_b64_tr_b16 a[206:207], v11 offset:12800
    buffer_load_dwordx4 a[156:159], v6, s[36:39], s12 offen offset:1024 sc1
    s_add_u32 s12, s12, 4096
    s_waitcnt lgkmcnt(4)
    v_mfma_f32_16x16x32_bf16 v[24:27], v[72:75], a[196:199], v[24:27]
    v_mfma_f32_16x16x32_bf16 v[28:31], v[136:139], a[196:199], v[28:31]
    v_mfma_f32_16x16x32_bf16 v[36:39], v[200:203], a[196:199], v[36:39]
    s_waitcnt lgkmcnt(2)
    v_mfma_f32_16x16x32_bf16 a[208:211], a[200:203], a[200:203], a[208:211]
    ds_read_b64_tr_b16 a[192:193], v8 offset:16384
    v_mfma_f32_16x16x32_bf16 v[16:19], v[76:79], a[200:203], v[16:19]
    ds_read_b64_tr_b16 a[194:195], v8 offset:16896
    buffer_load_dwordx4 a[32:35], v6, s[36:39], s7 offen offset:0 sc1
    v_mfma_f32_16x16x32_bf16 v[20:23], v[140:143], a[200:203], v[20:23]
    ds_read_b64_tr_b16 a[196:197], v11 offset:16384
    v_mfma_f32_16x16x32_bf16 v[32:35], v[204:207], a[200:203], v[32:35]
    ds_read_b64_tr_b16 a[198:199], v11 offset:16896
    s_waitcnt lgkmcnt(4)
    v_mfma_f32_16x16x32_bf16 v[24:27], v[76:79], a[204:207], v[24:27]
    v_mfma_f32_16x16x32_bf16 v[28:31], v[140:143], a[204:207], v[28:31]
    v_mfma_f32_16x16x32_bf16 v[36:39], v[204:207], a[204:207], v[36:39]
    buffer_load_dwordx4 a[96:99], v6, s[36:39], s7 offen offset:1024 sc1
    s_add_u32 s7, s7, 4096
    s_waitcnt lgkmcnt(2)
    v_mfma_f32_16x16x32_bf16 a[208:211], a[192:195], a[192:195], a[208:211]
    ds_read_b64_tr_b16 a[200:201], v8 offset:20480
    v_mfma_f32_16x16x32_bf16 v[16:19], v[80:83], a[192:195], v[16:19]
    ds_read_b64_tr_b16 a[202:203], v8 offset:20992
    v_mfma_f32_16x16x32_bf16 v[20:23], v[144:147], a[192:195], v[20:23]
    ds_read_b64_tr_b16 a[204:205], v11 offset:20480
    v_mfma_f32_16x16x32_bf16 v[32:35], v[208:211], a[192:195], v[32:35]
    ds_read_b64_tr_b16 a[206:207], v11 offset:20992
    s_waitcnt lgkmcnt(4)
    v_mfma_f32_16x16x32_bf16 v[24:27], v[80:83], a[196:199], v[24:27]
    buffer_load_dwordx4 a[160:163], v6, s[36:39], s12 offen offset:0 sc1
    v_mfma_f32_16x16x32_bf16 v[28:31], v[144:147], a[196:199], v[28:31]
    v_mfma_f32_16x16x32_bf16 v[36:39], v[208:211], a[196:199], v[36:39]
    s_waitcnt lgkmcnt(2)
    v_mfma_f32_16x16x32_bf16 a[208:211], a[200:203], a[200:203], a[208:211]
    ds_read_b64_tr_b16 a[192:193], v8 offset:24576
    v_mfma_f32_16x16x32_bf16 v[16:19], v[84:87], a[200:203], v[16:19]
    ds_read_b64_tr_b16 a[194:195], v8 offset:25088
    v_mfma_f32_16x16x32_bf16 v[20:23], v[148:151], a[200:203], v[20:23]
    ds_read_b64_tr_b16 a[196:197], v11 offset:24576
    buffer_load_dwordx4 a[36:39], v6, s[36:39], s12 offen offset:1024 sc1
    s_add_u32 s12, s12, 4096
    v_mfma_f32_16x16x32_bf16 v[32:35], v[212:215], a[200:203], v[32:35]
    ds_read_b64_tr_b16 a[198:199], v11 offset:25088
    s_waitcnt lgkmcnt(4)
    v_mfma_f32_16x16x32_bf16 v[24:27], v[84:87], a[204:207], v[24:27]
    v_mfma_f32_16x16x32_bf16 v[28:31], v[148:151], a[204:207], v[28:31]
    v_mfma_f32_16x16x32_bf16 v[36:39], v[212:215], a[204:207], v[36:39]
    s_waitcnt vmcnt(8)
    s_mov_b64 exec, 1
    v_mov_b32 v12, s52
    buffer_store_dword v12, v1, s[36:39], s28 offen offset:0
    buffer_store_dword v12, v1, s[36:39], s58 offen offset:0 sc1
    s_mov_b64 exec, -1
    buffer_load_dwordx4 a[244:247], v6, s[36:39], s20 offen sc1
    buffer_load_dwordx4 a[248:251], v9, s[36:39], s8 offen sc1
    buffer_load_dwordx4 a[244:247], v6, s[36:39], s21 offen sc1
    buffer_load_dwordx4 a[248:251], v9, s[36:39], s9 offen sc1
    s_waitcnt lgkmcnt(2)
    v_mfma_f32_16x16x32_bf16 a[208:211], a[192:195], a[192:195], a[208:211]
    ds_read_b64_tr_b16 a[200:201], v8 offset:28672
    buffer_load_dwordx4 a[100:103], v6, s[36:39], s7 offen offset:0 sc1
    v_mfma_f32_16x16x32_bf16 v[16:19], v[88:91], a[192:195], v[16:19]
    ds_read_b64_tr_b16 a[202:203], v8 offset:29184
    v_mfma_f32_16x16x32_bf16 v[20:23], v[152:155], a[192:195], v[20:23]
    ds_read_b64_tr_b16 a[204:205], v11 offset:28672
    v_mfma_f32_16x16x32_bf16 v[32:35], v[216:219], a[192:195], v[32:35]
    ds_read_b64_tr_b16 a[206:207], v11 offset:29184
    s_waitcnt lgkmcnt(4)
    v_mfma_f32_16x16x32_bf16 v[24:27], v[88:91], a[196:199], v[24:27]
    v_mfma_f32_16x16x32_bf16 v[28:31], v[152:155], a[196:199], v[28:31]
    buffer_load_dwordx4 a[164:167], v6, s[36:39], s7 offen offset:1024 sc1
    s_add_u32 s7, s7, 4096
    v_mfma_f32_16x16x32_bf16 v[36:39], v[216:219], a[196:199], v[36:39]
    s_waitcnt lgkmcnt(2)
    v_mfma_f32_16x16x32_bf16 a[208:211], a[200:203], a[200:203], a[208:211]
    ds_read_b64_tr_b16 a[192:193], v8 offset:32768
    v_mfma_f32_16x16x32_bf16 v[16:19], v[92:95], a[200:203], v[16:19]
    ds_read_b64_tr_b16 a[194:195], v8 offset:33280
    v_mfma_f32_16x16x32_bf16 v[20:23], v[156:159], a[200:203], v[20:23]
    ds_read_b64_tr_b16 a[196:197], v11 offset:32768
    v_mfma_f32_16x16x32_bf16 v[32:35], v[220:223], a[200:203], v[32:35]
    ds_read_b64_tr_b16 a[198:199], v11 offset:33280
    buffer_load_dwordx4 a[40:43], v6, s[36:39], s12 offen offset:0 sc1
    s_waitcnt lgkmcnt(4)
    v_mfma_f32_16x16x32_bf16 v[24:27], v[92:95], a[204:207], v[24:27]
    v_mfma_f32_16x16x32_bf16 v[28:31], v[156:159], a[204:207], v[28:31]
    v_mfma_f32_16x16x32_bf16 v[36:39], v[220:223], a[204:207], v[36:39]
    s_waitcnt lgkmcnt(2)
    v_mfma_f32_16x16x32_bf16 a[208:211], a[192:195], a[192:195], a[208:211]
    ds_read_b64_tr_b16 a[200:201], v8 offset:36864
    v_mfma_f32_16x16x32_bf16 v[16:19], v[96:99], a[192:195], v[16:19]
    ds_read_b64_tr_b16 a[202:203], v8 offset:37376
    buffer_load_dwordx4 a[104:107], v6, s[36:39], s12 offen offset:1024 sc1
    s_add_u32 s12, s12, 4096
    v_mfma_f32_16x16x32_bf16 v[20:23], v[160:163], a[192:195], v[20:23]
    ds_read_b64_tr_b16 a[204:205], v11 offset:36864
    v_mfma_f32_16x16x32_bf16 v[32:35], v[224:227], a[192:195], v[32:35]
    ds_read_b64_tr_b16 a[206:207], v11 offset:37376
    s_waitcnt lgkmcnt(4)
    v_mfma_f32_16x16x32_bf16 v[24:27], v[96:99], a[196:199], v[24:27]
    v_mfma_f32_16x16x32_bf16 v[28:31], v[160:163], a[196:199], v[28:31]
    v_mfma_f32_16x16x32_bf16 v[36:39], v[224:227], a[196:199], v[36:39]
    buffer_load_dwordx4 a[168:171], v6, s[36:39], s7 offen offset:0 sc1
    s_waitcnt lgkmcnt(2)
    v_mfma_f32_16x16x32_bf16 a[208:211], a[200:203], a[200:203], a[208:211]
    ds_read_b64_tr_b16 a[192:193], v8 offset:40960
    v_mfma_f32_16x16x32_bf16 v[16:19], v[100:103], a[200:203], v[16:19]
    ds_read_b64_tr_b16 a[194:195], v8 offset:41472
    v_mfma_f32_16x16x32_bf16 v[20:23], v[164:167], a[200:203], v[20:23]
    ds_read_b64_tr_b16 a[196:197], v11 offset:40960
    v_mfma_f32_16x16x32_bf16 v[32:35], v[228:231], a[200:203], v[32:35]
    ds_read_b64_tr_b16 a[198:199], v11 offset:41472
    s_waitcnt lgkmcnt(4)
    v_mfma_f32_16x16x32_bf16 v[24:27], v[100:103], a[204:207], v[24:27]
    buffer_load_dwordx4 a[44:47], v6, s[36:39], s7 offen offset:1024 sc1
    s_add_u32 s7, s7, 4096
    v_mfma_f32_16x16x32_bf16 v[28:31], v[164:167], a[204:207], v[28:31]
    v_mfma_f32_16x16x32_bf16 v[36:39], v[228:231], a[204:207], v[36:39]
    s_waitcnt lgkmcnt(2)
    v_mfma_f32_16x16x32_bf16 a[208:211], a[192:195], a[192:195], a[208:211]
    ds_read_b64_tr_b16 a[200:201], v8 offset:45056
    v_mfma_f32_16x16x32_bf16 v[16:19], v[104:107], a[192:195], v[16:19]
    ds_read_b64_tr_b16 a[202:203], v8 offset:45568
    v_mfma_f32_16x16x32_bf16 v[20:23], v[168:171], a[192:195], v[20:23]
    ds_read_b64_tr_b16 a[204:205], v11 offset:45056
    buffer_load_dwordx4 a[108:111], v6, s[36:39], s12 offen offset:0 sc1
    v_mfma_f32_16x16x32_bf16 v[32:35], v[232:235], a[192:195], v[32:35]
    ds_read_b64_tr_b16 a[206:207], v11 offset:45568
    s_waitcnt lgkmcnt(4)
    v_mfma_f32_16x16x32_bf16 v[24:27], v[104:107], a[196:199], v[24:27]
    v_mfma_f32_16x16x32_bf16 v[28:31], v[168:171], a[196:199], v[28:31]
    v_mfma_f32_16x16x32_bf16 v[36:39], v[232:235], a[196:199], v[36:39]
    s_waitcnt lgkmcnt(2)
    v_mfma_f32_16x16x32_bf16 a[208:211], a[200:203], a[200:203], a[208:211]
    ds_read_b64_tr_b16 a[192:193], v8 offset:49152
    buffer_load_dwordx4 a[172:175], v6, s[36:39], s12 offen offset:1024 sc1
    s_add_u32 s12, s12, 4096
    v_mfma_f32_16x16x32_bf16 v[16:19], v[108:111], a[200:203], v[16:19]
    ds_read_b64_tr_b16 a[194:195], v8 offset:49664
    v_mfma_f32_16x16x32_bf16 v[20:23], v[172:175], a[200:203], v[20:23]
    ds_read_b64_tr_b16 a[196:197], v11 offset:49152
    v_mfma_f32_16x16x32_bf16 v[32:35], v[236:239], a[200:203], v[32:35]
    ds_read_b64_tr_b16 a[198:199], v11 offset:49664
    s_waitcnt lgkmcnt(4)
    v_mfma_f32_16x16x32_bf16 v[24:27], v[108:111], a[204:207], v[24:27]
    v_mfma_f32_16x16x32_bf16 v[28:31], v[172:175], a[204:207], v[28:31]
    buffer_load_dwordx4 a[48:51], v6, s[36:39], s7 offen offset:0 sc1
    v_mfma_f32_16x16x32_bf16 v[36:39], v[236:239], a[204:207], v[36:39]
    s_waitcnt lgkmcnt(2)
    v_mfma_f32_16x16x32_bf16 a[208:211], a[192:195], a[192:195], a[208:211]
    ds_read_b64_tr_b16 a[200:201], v8 offset:53248
    v_mfma_f32_16x16x32_bf16 v[16:19], v[112:115], a[192:195], v[16:19]
    ds_read_b64_tr_b16 a[202:203], v8 offset:53760
    v_mfma_f32_16x16x32_bf16 v[20:23], v[176:179], a[192:195], v[20:23]
    ds_read_b64_tr_b16 a[204:205], v11 offset:53248
    v_mfma_f32_16x16x32_bf16 v[32:35], v[240:243], a[192:195], v[32:35]
    ds_read_b64_tr_b16 a[206:207], v11 offset:53760
    buffer_load_dwordx4 a[112:115], v6, s[36:39], s7 offen offset:1024 sc1
    s_add_u32 s7, s7, 4096
    s_waitcnt lgkmcnt(4)
    v_mfma_f32_16x16x32_bf16 v[24:27], v[112:115], a[196:199], v[24:27]
    v_mfma_f32_16x16x32_bf16 v[28:31], v[176:179], a[196:199], v[28:31]
    v_mfma_f32_16x16x32_bf16 v[36:39], v[240:243], a[196:199], v[36:39]
    buffer_load_dwordx4 a[176:179], v6, s[36:39], s12 offen offset:0 sc1
    buffer_load_dwordx4 a[52:55], v6, s[36:39], s12 offen offset:1024 sc1
    s_add_u32 s12, s12, 4096
    s_cmp_eq_u32 s53, 3
    s_cselect_b32 s7, 0x7f000000, s7
    s_cselect_b32 s12, 0x7f000000, s12
    buffer_load_dwordx4 a[116:119], v6, s[36:39], s7 offen offset:0 sc1
    buffer_load_dwordx4 a[180:183], v6, s[36:39], s7 offen offset:1024 sc1
    buffer_load_dwordx4 a[56:59], v6, s[36:39], s12 offen offset:0 sc1
    buffer_load_dwordx4 a[120:123], v6, s[36:39], s12 offen offset:1024 sc1
    buffer_load_dwordx4 a[240:243], v10, s[36:39], s60 offen offset:0 sc1
    s_waitcnt lgkmcnt(2)
    v_mfma_f32_16x16x32_bf16 a[208:211], a[200:203], a[200:203], a[208:211]
    ds_read_b64_tr_b16 a[192:193], v8 offset:57344
    v_mfma_f32_16x16x32_bf16 v[16:19], v[116:119], a[200:203], v[16:19]
    ds_read_b64_tr_b16 a[194:195], v8 offset:57856
    v_mfma_f32_16x16x32_bf16 v[20:23], v[180:183], a[200:203], v[20:23]
    ds_read_b64_tr_b16 a[196:197], v11 offset:57344
    v_mfma_f32_16x16x32_bf16 v[32:35], v[244:247], a[200:203], v[32:35]
    ds_read_b64_tr_b16 a[198:199], v11 offset:57856
    s_waitcnt lgkmcnt(4)
    v_mfma_f32_16x16x32_bf16 v[24:27], v[116:119], a[204:207], v[24:27]
    v_mfma_f32_16x16x32_bf16 v[28:31], v[180:183], a[204:207], v[28:31]
    v_mfma_f32_16x16x32_bf16 v[36:39], v[244:247], a[204:207], v[36:39]
    s_waitcnt lgkmcnt(2)
    v_mfma_f32_16x16x32_bf16 a[208:211], a[192:195], a[192:195], a[208:211]
    ds_read_b64_tr_b16 a[200:201], v8 offset:61440
    v_mfma_f32_16x16x32_bf16 v[16:19], v[120:123], a[192:195], v[16:19]
    ds_read_b64_tr_b16 a[202:203], v8 offset:61952
    v_mfma_f32_16x16x32_bf16 v[20:23], v[184:187], a[192:195], v[20:23]
    ds_read_b64_tr_b16 a[204:205], v11 offset:61440
    v_mfma_f32_16x16x32_bf16 v[32:35], v[248:251], a[192:195], v[32:35]
    ds_read_b64_tr_b16 a[206:207], v11 offset:61952
    s_waitcnt lgkmcnt(4)
    v_mfma_f32_16x16x32_bf16 v[24:27], v[120:123], a[196:199], v[24:27]
    v_mfma_f32_16x16x32_bf16 v[28:31], v[184:187], a[196:199], v[28:31]
    v_mfma_f32_16x16x32_bf16 v[36:39], v[248:251], a[196:199], v[36:39]
    s_waitcnt lgkmcnt(2)
    v_mfma_f32_16x16x32_bf16 a[208:211], a[200:203], a[200:203], a[208:211]
    v_add_u32 v4, s18, v7
    v_add_u32 v5, s19, v7
    v_mfma_f32_16x16x32_bf16 v[32:35], v[252:255], a[200:203], v[32:35]
    v_xor_b32 v8, 64, v8
    v_xor_b32 v11, 64, v11
    s_waitcnt lgkmcnt(0)
    v_mfma_f32_16x16x32_bf16 v[36:39], v[252:255], a[204:207], v[36:39]
    v_mfma_f32_16x16x32_bf16 v[16:19], v[124:127], a[200:203], v[16:19]
    v_mfma_f32_16x16x32_bf16 v[20:23], v[188:191], a[200:203], v[20:23]
    v_mfma_f32_16x16x32_bf16 v[24:27], v[124:127], a[204:207], v[24:27]
    v_mfma_f32_16x16x32_bf16 v[28:31], v[188:191], a[204:207], v[28:31]
    v_accvgpr_read_b32 v12, a208
    v_accvgpr_read_b32 v13, a209
    v_accvgpr_read_b32 v14, a210
    v_accvgpr_read_b32 v15, a211
    v_cndmask_b32 v12, v12, v13, s[64:65]
    v_cndmask_b32 v12, v12, v14, s[66:67]
    v_cndmask_b32 v12, v12, v15, s[68:69]
    s_mov_b32 exec_lo, 0x00f0000f
    s_mov_b32 exec_hi, 0xf0000f00
    ds_write_b32 v4, v12 offset:4
    s_mov_b64 exec, -1
    s_cmp_lg_u32 s48, 3
    s_cbranch_scc1 L_sum_30
    ds_write_b32 v4, v32
    ds_write_b32 v5, v36
L_sum_30:
    s_waitcnt lgkmcnt(0)
    s_barrier
    ds_read_b64 v[12:13], v4
    ds_read_b64 v[14:15], v5
    v_mov_b32 v4, s10
    v_mov_b32 v5, s11
    v_cmp_gt_u32 vcc, 32, v1
    s_nop 1
    v_cndmask_b32 v4, v5, v4, vcc
    v_add_u32 v4, v4, v9
    s_waitcnt lgkmcnt(0)
    v_pk_mul_f32 v[12:13], v[12:13], s[62:63] op_sel_hi:[1,0]
    v_pk_mul_f32 v[14:15], v[14:15], s[62:63] op_sel_hi:[1,0]
    v_fma_f32 v13, -v12, v12, v13
    v_fma_f32 v15, -v14, v14, v15
    v_max_f32 v13, 0, v13
    v_max_f32 v15, 0, v15
    v_add_f32 v13, 0x3727c5ac, v13
    v_add_f32 v15, 0x3727c5ac, v15
    v_rsq_f32 v13, v13
    v_rsq_f32 v15, v15
    v_pk_fma_f32 v[16:17], v[40:41], v[12:13], v[16:17] op_sel_hi:[1,0,1] neg_lo:[0,1,0] neg_hi:[0,1,0]
    v_pk_fma_f32 v[18:19], v[42:43], v[12:13], v[18:19] op_sel_hi:[1,0,1] neg_lo:[0,1,0] neg_hi:[0,1,0]
    v_pk_fma_f32 v[16:17], v[16:17], v[12:13], v[44:45] op_sel:[0,1,0] op_sel_hi:[1,1,1]
    v_pk_fma_f32 v[18:19], v[18:19], v[12:13], v[46:47] op_sel:[0,1,0] op_sel_hi:[1,1,1]
    v_pk_fma_f32 v[20:21], v[48:49], v[12:13], v[20:21] op_sel_hi:[1,0,1] neg_lo:[0,1,0] neg_hi:[0,1,0]
    v_pk_fma_f32 v[22:23], v[50:51], v[12:13], v[22:23] op_sel_hi:[1,0,1] neg_lo:[0,1,0] neg_hi:[0,1,0]
    v_pk_fma_f32 v[20:21], v[20:21], v[12:13], v[52:53] op_sel:[0,1,0] op_sel_hi:[1,1,1]
    v_pk_fma_f32 v[22:23], v[22:23], v[12:13], v[54:55] op_sel:[0,1,0] op_sel_hi:[1,1,1]
    v_cvt_pk_bf16_f32 v16, v16, v17
    v_cvt_pk_bf16_f32 v17, v18, v19
    v_cvt_pk_bf16_f32 v18, v20, v21
    v_cvt_pk_bf16_f32 v19, v22, v23
    v_pk_max_i16 v16, v16, 0
    v_pk_max_i16 v17, v17, 0
    v_pk_max_i16 v18, v18, 0
    v_pk_max_i16 v19, v19, 0
    buffer_store_dwordx4 v[16:19], v6, s[36:39], s22 offen sc1
    v_pk_fma_f32 v[24:25], v[40:41], v[14:15], v[24:25] op_sel_hi:[1,0,1] neg_lo:[0,1,0] neg_hi:[0,1,0]
    v_pk_fma_f32 v[26:27], v[42:43], v[14:15], v[26:27] op_sel_hi:[1,0,1] neg_lo:[0,1,0] neg_hi:[0,1,0]
    v_pk_fma_f32 v[24:25], v[24:25], v[14:15], v[44:45] op_sel:[0,1,0] op_sel_hi:[1,1,1]
    v_pk_fma_f32 v[26:27], v[26:27], v[14:15], v[46:47] op_sel:[0,1,0] op_sel_hi:[1,1,1]
    v_pk_fma_f32 v[28:29], v[48:49], v[14:15], v[28:29] op_sel_hi:[1,0,1] neg_lo:[0,1,0] neg_hi:[0,1,0]
    v_pk_fma_f32 v[30:31], v[50:51], v[14:15], v[30:31] op_sel_hi:[1,0,1] neg_lo:[0,1,0] neg_hi:[0,1,0]
    v_pk_fma_f32 v[28:29], v[28:29], v[14:15], v[52:53] op_sel:[0,1,0] op_sel_hi:[1,1,1]
    v_pk_fma_f32 v[30:31], v[30:31], v[14:15], v[54:55] op_sel:[0,1,0] op_sel_hi:[1,1,1]
    v_cvt_pk_bf16_f32 v24, v24, v25
    v_cvt_pk_bf16_f32 v25, v26, v27
    v_cvt_pk_bf16_f32 v26, v28, v29
    v_cvt_pk_bf16_f32 v27, v30, v31
    v_pk_max_i16 v24, v24, 0
    v_pk_max_i16 v25, v25, 0
    v_pk_max_i16 v26, v26, 0
    v_pk_max_i16 v27, v27, 0
    buffer_store_dwordx4 v[24:27], v6, s[36:39], s23 offen sc1
    v_pk_fma_f32 v[32:33], v[56:57], v[12:13], v[32:33] op_sel_hi:[1,0,1] neg_lo:[0,1,0] neg_hi:[0,1,0]
    v_pk_fma_f32 v[34:35], v[58:59], v[12:13], v[34:35] op_sel_hi:[1,0,1] neg_lo:[0,1,0] neg_hi:[0,1,0]
    v_pk_fma_f32 v[32:33], v[32:33], v[12:13], v[60:61] op_sel:[0,1,0] op_sel_hi:[1,1,1]
    v_pk_fma_f32 v[34:35], v[34:35], v[12:13], v[62:63] op_sel:[0,1,0] op_sel_hi:[1,1,1]
    v_pk_fma_f32 v[36:37], v[56:57], v[14:15], v[36:37] op_sel_hi:[1,0,1] neg_lo:[0,1,0] neg_hi:[0,1,0]
    v_pk_fma_f32 v[38:39], v[58:59], v[14:15], v[38:39] op_sel_hi:[1,0,1] neg_lo:[0,1,0] neg_hi:[0,1,0]
    v_pk_fma_f32 v[36:37], v[36:37], v[14:15], v[60:61] op_sel:[0,1,0] op_sel_hi:[1,1,1]
    v_pk_fma_f32 v[38:39], v[38:39], v[14:15], v[62:63] op_sel:[0,1,0] op_sel_hi:[1,1,1]
    v_cvt_pk_bf16_f32 v32, v32, v33
    v_cvt_pk_bf16_f32 v33, v34, v35
    v_cvt_pk_bf16_f32 v34, v36, v37
    v_cvt_pk_bf16_f32 v35, v38, v39
    v_pk_max_i16 v32, v32, 0
    v_pk_max_i16 v33, v33, 0
    v_pk_max_i16 v34, v34, 0
    v_pk_max_i16 v35, v35, 0
    s_nop 0
    v_permlane32_swap_b32 v32, v34
    v_permlane32_swap_b32 v33, v35
    buffer_store_dwordx4 v[32:35], v4, s[36:39], 0 offen sc1
    s_waitcnt vmcnt(3)
    v_accvgpr_read_b32 v248, a240
    v_accvgpr_read_b32 v249, a241
    v_accvgpr_read_b32 v250, a242
    v_accvgpr_read_b32 v251, a243
    v_xor_b32 v248, s52, v248
    v_xor_b32 v249, s52, v249
    v_xor_b32 v250, s52, v250
    v_xor_b32 v251, s52, v251
    v_or3_b32 v248, v248, v249, v250
    v_or_b32 v248, v248, v251
    v_cmp_ne_u32 vcc, 0, v248
    s_cbranch_vccnz L_slow_31
L_back_32:
    s_xor_b32 s59, s75, 1
    s_lshl_b32 s55, s72, 2
    s_add_u32 s59, s59, s55
    s_mul_i32 s59, s59, 44032
    s_add_u32 s59, s59, s24
    buffer_load_dwordx4 v[64:67], v6, s[36:39], s59 offen offset:0 sc1
    buffer_load_dwordx4 v[68:71], v6, s[36:39], s59 offen offset:1024 sc1
    buffer_load_dwordx4 v[72:75], v6, s[36:39], s59 offen offset:2048 sc1
    buffer_load_dwordx4 v[76:79], v6, s[36:39], s59 offen offset:3072 sc1
    s_add_u32 s59, s59, 4096
    buffer_load_dwordx4 v[80:83], v6, s[36:39], s59 offen offset:0 sc1
    buffer_load_dwordx4 v[84:87], v6, s[36:39], s59 offen offset:1024 sc1
    buffer_load_dwordx4 v[88:91], v6, s[36:39], s59 offen offset:2048 sc1
    buffer_load_dwordx4 v[92:95], v6, s[36:39], s59 offen offset:3072 sc1
    s_add_u32 s59, s59, 4096
    s_xor_b32 s26, s71, s75
    s_lshl_b32 s26, s26, 5
    v_xor_b32 v4, s26, v8
    s_lshl_b32 s26, s73, 13
    s_lshl_b32 s27, s71, 12
    s_add_u32 s26, s26, s27
    v_add_u32 v4, s26, v4
    v_xor_b32 v5, 64, v4
    ds_read_b64_tr_b16 v[48:49], v4 offset:0
    ds_read_b64_tr_b16 v[50:51], v4 offset:512
    ds_read_b64_tr_b16 v[52:53], v5 offset:0
    ds_read_b64_tr_b16 v[54:55], v5 offset:512
    s_lshl_b32 s26, s71, 7
    s_add_u32 s26, s26, 76800
    v_lshl_add_u32 v5, v3, 5, s26
    ds_read_b128 v[208:211], v5 offset:0
    ds_read_b128 v[212:215], v5 offset:16
    ds_read_b128 v[216:219], v5 offset:256
    ds_read_b128 v[220:223], v5 offset:272
    ds_read_b128 v[224:227], v5 offset:512
    ds_read_b128 v[228:231], v5 offset:528
    ds_read_b128 v[232:235], v5 offset:768
    ds_read_b128 v[236:239], v5 offset:784
    s_xor_b32 s26, s48, 1
    s_mul_i32 s26, s26, 6144
    s_add_u32 s26, s26, 98304
    v_add_u32 v16, s26, v6
    s_xor_b32 s26, s48, 2
    s_mul_i32 s26, s26, 6144
    s_add_u32 s26, s26, 100352
    s_waitcnt vmcnt(8)
    s_mov_b64 exec, 1
    v_mov_b32 v12, s52
    buffer_store_dword v12, v1, s[36:39], s28 offen offset:16
    buffer_store_dword v12, v1, s[36:39], s58 offen offset:16 sc1
    s_mov_b64 exec, -1
    s_waitcnt vmcnt(9)
    v_mfma_f32_16x16x32_bf16 a[200:203], a[0:3], v[64:67], 0
    buffer_load_dwordx4 v[96:99], v6, s[36:39], s59 offen offset:0 sc1
    v_add_u32 v17, s26, v6
    s_xor_b32 s26, s48, 3
    v_mfma_f32_16x16x32_bf16 a[204:207], a[64:67], v[64:67], 0
    s_mul_i32 s26, s26, 6144
    s_add_u32 s26, s26, 102400
    v_mfma_f32_16x16x32_bf16 a[208:211], a[128:131], v[64:67], 0
    v_add_u32 v18, s26, v6
    s_mul_i32 s26, s48, 6144
    v_mfma_f32_16x16x32_bf16 a[212:215], a[4:7], v[64:67], 0
    s_add_u32 s26, s26, 98304
    v_add_u32 v19, s26, v6
    s_waitcnt vmcnt(9)
    v_mfma_f32_16x16x32_bf16 a[200:203], a[68:71], v[68:71], a[200:203]
    buffer_load_dwordx4 v[100:103], v6, s[36:39], s59 offen offset:1024 sc1
    s_lshr_b32 s26, s72, 3
    s_lshl_b32 s26, s26, 19
    v_mfma_f32_16x16x32_bf16 a[204:207], a[132:135], v[68:71], a[204:207]
    s_and_b32 s27, s72, 1
    s_lshl_b32 s27, s27, 18
    v_mfma_f32_16x16x32_bf16 a[208:211], a[8:11], v[68:71], a[208:211]
    s_add_u32 s26, s26, s27
    s_bfe_u32 s27, s72, 0x20001
    v_mfma_f32_16x16x32_bf16 a[212:215], a[72:75], v[68:71], a[212:215]
    s_lshl_b32 s27, s27, 13
    s_add_u32 s26, s26, s27
    s_waitcnt vmcnt(9)
    v_mfma_f32_16x16x32_bf16 a[200:203], a[136:139], v[72:75], a[200:203]
    s_add_u32 s59, s59, s25
    buffer_load_dwordx4 v[104:107], v6, s[36:39], s59 offen offset:2048 sc1
    s_lshl_b32 s27, s75, 16
    s_add_u32 s26, s26, s27
    v_mfma_f32_16x16x32_bf16 a[204:207], a[12:15], v[72:75], a[204:207]
    s_lshl_b32 s27, s73, 7
    s_add_u32 s26, s26, s27
    v_mfma_f32_16x16x32_bf16 a[208:211], a[76:79], v[72:75], a[208:211]
    s_lshl_b32 s27, s71, 6
    s_add_u32 s26, s26, s27
    v_mfma_f32_16x16x32_bf16 a[212:215], a[140:143], v[72:75], a[212:215]
    v_and_b32 v20, 8, v2
    v_mul_u32_u24 v20, 3, v20
    s_waitcnt vmcnt(9)
    v_mfma_f32_16x16x32_bf16 a[200:203], a[16:19], v[76:79], a[200:203]
    s_xor_b32 s59, s75, 0
    s_lshl_b32 s55, s72, 2
    s_add_u32 s59, s59, s55
    s_mul_i32 s59, s59, 44032
    s_add_u32 s59, s59, s24
    buffer_load_dwordx4 v[108:111], v6, s[36:39], s59 offen offset:0 sc1
    v_add_u32 v20, v20, v2
    v_lshlrev_b32 v20, 10, v20
    v_mfma_f32_16x16x32_bf16 a[204:207], a[80:83], v[76:79], a[204:207]
    v_lshl_add_u32 v20, v3, 4, v20
    v_add_u32 v20, s26, v20
    v_mfma_f32_16x16x32_bf16 a[208:211], a[144:147], v[76:79], a[208:211]
    s_waitcnt lgkmcnt(0)
    v_lshlrev_b32 v24, 16, v48
    v_mfma_f32_16x16x32_bf16 a[212:215], a[20:23], v[76:79], a[212:215]
    v_and_b32 v25, s51, v48
    v_lshlrev_b32 v26, 16, v49
    s_waitcnt vmcnt(9)
    v_mfma_f32_16x16x32_bf16 a[200:203], a[84:87], v[80:83], a[200:203]
    buffer_load_dwordx4 v[112:115], v6, s[36:39], s59 offen offset:1024 sc1
    v_and_b32 v27, s51, v49
    v_lshlrev_b32 v28, 16, v50
    v_mfma_f32_16x16x32_bf16 a[204:207], a[148:151], v[80:83], a[204:207]
    v_and_b32 v29, s51, v50
    v_lshlrev_b32 v30, 16, v51
    v_mfma_f32_16x16x32_bf16 a[208:211], a[24:27], v[80:83], a[208:211]
    v_and_b32 v31, s51, v51
    v_lshlrev_b32 v32, 16, v52
    v_mfma_f32_16x16x32_bf16 a[212:215], a[88:91], v[80:83], a[212:215]
    v_and_b32 v33, s51, v52
    v_lshlrev_b32 v34, 16, v53
    s_waitcnt vmcnt(9)
    v_mfma_f32_16x16x32_bf16 a[200:203], a[152:155], v[84:87], a[200:203]
    buffer_load_dwordx4 v[116:119], v6, s[36:39], s59 offen offset:2048 sc1
    v_and_b32 v35, s51, v53
    v_lshlrev_b32 v36, 16, v54
    v_mfma_f32_16x16x32_bf16 a[204:207], a[28:31], v[84:87], a[204:207]
    v_and_b32 v37, s51, v54
    v_lshlrev_b32 v38, 16, v55
    v_mfma_f32_16x16x32_bf16 a[208:211], a[92:95], v[84:87], a[208:211]
    v_and_b32 v39, s51, v55
    v_add_f32 v208, v208, v216
    v_mfma_f32_16x16x32_bf16 a[212:215], a[156:159], v[84:87], a[212:215]
    v_add_f32 v209, v209, v217
    v_add_f32 v210, v210, v218
    s_waitcnt vmcnt(9)
    v_mfma_f32_16x16x32_bf16 a[200:203], a[32:35], v[88:91], a[200:203]
    buffer_load_dwordx4 v[120:123], v6, s[36:39], s59 offen offset:3072 sc1
    s_add_u32 s59, s59, 4096
    v_add_f32 v211, v211, v219
    v_add_f32 v212, v212, v220
    v_mfma_f32_16x16x32_bf16 a[204:207], a[96:99], v[88:91], a[204:207]
    v_add_f32 v213, v213, v221
    v_add_f32 v214, v214, v222
    v_mfma_f32_16x16x32_bf16 a[208:211], a[160:163], v[88:91], a[208:211]
    v_add_f32 v215, v215, v223
    v_add_f32 v208, v208, v224
    v_mfma_f32_16x16x32_bf16 a[212:215], a[36:39], v[88:91], a[212:215]
    v_add_f32 v209, v209, v225
    v_add_f32 v210, v210, v226
    s_waitcnt vmcnt(9)
    v_mfma_f32_16x16x32_bf16 a[200:203], a[100:103], v[92:95], a[200:203]
    buffer_load_dwordx4 v[124:127], v6, s[36:39], s59 offen offset:0 sc1
    v_add_f32 v211, v211, v227
    v_add_f32 v212, v212, v228
    v_mfma_f32_16x16x32_bf16 a[204:207], a[164:167], v[92:95], a[204:207]
    v_add_f32 v213, v213, v229
    v_add_f32 v214, v214, v230
    v_mfma_f32_16x16x32_bf16 a[208:211], a[40:43], v[92:95], a[208:211]
    v_add_f32 v215, v215, v231
    v_add_f32 v208, v208, v232
    v_mfma_f32_16x16x32_bf16 a[212:215], a[104:107], v[92:95], a[212:215]
    v_add_f32 v209, v209, v233
    v_add_f32 v210, v210, v234
    s_waitcnt vmcnt(7)
    v_mfma_f32_16x16x32_bf16 a[200:203], a[168:171], v[96:99], a[200:203]
    buffer_load_dwordx4 v[128:131], v6, s[36:39], s59 offen offset:1024 sc1
    v_add_f32 v211, v211, v235
    v_add_f32 v212, v212, v236
    v_mfma_f32_16x16x32_bf16 a[204:207], a[44:47], v[96:99], a[204:207]
    v_add_f32 v213, v213, v237
    v_add_f32 v214, v214, v238
    v_mfma_f32_16x16x32_bf16 a[208:211], a[108:111], v[96:99], a[208:211]
    v_add_f32 v215, v215, v239
    v_cvt_pk_bf16_f32 v216, v208, v209
    v_mfma_f32_16x16x32_bf16 a[212:215], a[172:175], v[96:99], a[212:215]
    v_cvt_pk_bf16_f32 v217, v210, v211
    v_cvt_pk_bf16_f32 v218, v212, v213
    s_waitcnt vmcnt(7)
    v_mfma_f32_16x16x32_bf16 a[200:203], a[48:51], v[100:103], a[200:203]
    buffer_load_dwordx4 v[132:135], v6, s[36:39], s59 offen offset:2048 sc1
    v_cvt_pk_bf16_f32 v219, v214, v215
    v_lshlrev_b32 v56, 16, v216
    v_mfma_f32_16x16x32_bf16 a[204:207], a[112:115], v[100:103], a[204:207]
    v_and_b32 v57, s51, v216
    v_lshlrev_b32 v58, 16, v217
    v_mfma_f32_16x16x32_bf16 a[208:211], a[176:179], v[100:103], a[208:211]
    v_and_b32 v59, s51, v217
    v_lshlrev_b32 v60, 16, v218
    v_mfma_f32_16x16x32_bf16 a[212:215], a[52:55], v[100:103], a[212:215]
    v_and_b32 v61, s51, v218
    v_lshlrev_b32 v62, 16, v219
    s_waitcnt vmcnt(7)
    v_mfma_f32_16x16x32_bf16 a[200:203], a[116:119], v[104:107], a[200:203]
    buffer_load_dwordx4 v[136:139], v6, s[36:39], s59 offen offset:3072 sc1
    s_add_u32 s59, s59, 4096
    v_and_b32 v63, s51, v219
    v_mfma_f32_16x16x32_bf16 a[204:207], a[180:183], v[104:107], a[204:207]
    v_mfma_f32_16x16x32_bf16 a[208:211], a[56:59], v[104:107], a[208:211]
    v_mfma_f32_16x16x32_bf16 a[212:215], a[120:123], v[104:107], a[212:215]
    s_waitcnt vmcnt(7)
    v_mfma_f32_16x16x32_bf16 v[40:43], a[0:3], v[108:111], 0
    buffer_load_dwordx4 v[140:143], v6, s[36:39], s59 offen offset:0 sc1
    v_mfma_f32_16x16x32_bf16 v[44:47], a[64:67], v[108:111], 0
    v_mfma_f32_16x16x32_bf16 a[192:195], a[128:131], v[108:111], 0
    v_mfma_f32_16x16x32_bf16 a[196:199], a[4:7], v[108:111], 0
    s_waitcnt vmcnt(7)
    v_mfma_f32_16x16x32_bf16 v[40:43], a[68:71], v[112:115], v[40:43]
    buffer_load_dwordx4 v[144:147], v6, s[36:39], s59 offen offset:1024 sc1
    v_mfma_f32_16x16x32_bf16 v[44:47], a[132:135], v[112:115], v[44:47]
    v_mfma_f32_16x16x32_bf16 a[192:195], a[8:11], v[112:115], a[192:195]
    v_mfma_f32_16x16x32_bf16 a[196:199], a[72:75], v[112:115], a[196:199]
    s_waitcnt vmcnt(7)
    v_mfma_f32_16x16x32_bf16 v[40:43], a[136:139], v[116:119], v[40:43]
    s_add_u32 s59, s59, s25
    buffer_load_dwordx4 v[148:151], v6, s[36:39], s59 offen offset:2048 sc1
    ds_write_b128 v17, a[200:203] offset:0
    v_mfma_f32_16x16x32_bf16 v[44:47], a[12:15], v[116:119], v[44:47]
    ds_write_b128 v17, a[204:207] offset:1024
    v_mfma_f32_16x16x32_bf16 a[192:195], a[76:79], v[116:119], a[192:195]
    ds_write_b128 v18, a[208:211] offset:0
    v_mfma_f32_16x16x32_bf16 a[196:199], a[140:143], v[116:119], a[196:199]
    ds_write_b128 v18, a[212:215] offset:1024
    buffer_load_dwordx4 a[240:243], v10, s[36:39], s60 offen offset:16 sc1
    s_waitcnt vmcnt(8)
    v_mfma_f32_16x16x32_bf16 v[40:43], a[16:19], v[120:123], v[40:43]
    v_mfma_f32_16x16x32_bf16 v[44:47], a[80:83], v[120:123], v[44:47]
    v_mfma_f32_16x16x32_bf16 a[192:195], a[144:147], v[120:123], a[192:195]
    v_mfma_f32_16x16x32_bf16 a[196:199], a[20:23], v[120:123], a[196:199]
    s_waitcnt vmcnt(7)
    v_mfma_f32_16x16x32_bf16 v[40:43], a[84:87], v[124:127], v[40:43]
    v_mfma_f32_16x16x32_bf16 v[44:47], a[148:151], v[124:127], v[44:47]
    v_mfma_f32_16x16x32_bf16 a[192:195], a[24:27], v[124:127], a[192:195]
    v_mfma_f32_16x16x32_bf16 a[196:199], a[88:91], v[124:127], a[196:199]
    s_waitcnt vmcnt(6)
    v_mfma_f32_16x16x32_bf16 v[40:43], a[152:155], v[128:131], v[40:43]
    v_mfma_f32_16x16x32_bf16 v[44:47], a[28:31], v[128:131], v[44:47]
    v_mfma_f32_16x16x32_bf16 a[192:195], a[92:95], v[128:131], a[192:195]
    v_mfma_f32_16x16x32_bf16 a[196:199], a[156:159], v[128:131], a[196:199]
    s_waitcnt vmcnt(5)
    v_mfma_f32_16x16x32_bf16 v[40:43], a[32:35], v[132:135], v[40:43]
    v_mfma_f32_16x16x32_bf16 v[44:47], a[96:99], v[132:135], v[44:47]
    v_mfma_f32_16x16x32_bf16 a[192:195], a[160:163], v[132:135], a[192:195]
    v_mfma_f32_16x16x32_bf16 a[196:199], a[36:39], v[132:135], a[196:199]
    s_waitcnt vmcnt(4)
    v_mfma_f32_16x16x32_bf16 v[40:43], a[100:103], v[136:139], v[40:43]
    v_mfma_f32_16x16x32_bf16 v[44:47], a[164:167], v[136:139], v[44:47]
    v_mfma_f32_16x16x32_bf16 a[192:195], a[40:43], v[136:139], a[192:195]
    v_mfma_f32_16x16x32_bf16 a[196:199], a[104:107], v[136:139], a[196:199]
    s_waitcnt vmcnt(0)
    v_accvgpr_read_b32 v248, a240
    v_accvgpr_read_b32 v249, a241
    v_accvgpr_read_b32 v250, a242
    v_accvgpr_read_b32 v251, a243
    v_xor_b32 v248, s52, v248
    v_xor_b32 v249, s52, v249
    v_xor_b32 v250, s52, v250
    v_xor_b32 v251, s52, v251
    v_or3_b32 v248, v248, v249, v250
    v_or_b32 v248, v248, v251
    v_cmp_ne_u32 vcc, 0, v248
    s_cbranch_vccnz L_slow_33
L_back_34:
    v_mfma_f32_16x16x32_bf16 v[40:43], a[168:171], v[140:143], v[40:43]
    s_xor_b32 s59, s75, 1
    s_lshl_b32 s55, s72, 2
    s_add_u32 s59, s59, s55
    s_mul_i32 s59, s59, 44032
    s_add_u32 s59, s59, s24
    s_add_u32 s59, s59, 88064
    buffer_load_dwordx4 v[152:155], v6, s[36:39], s59 offen offset:0 sc1
    v_mfma_f32_16x16x32_bf16 v[44:47], a[44:47], v[140:143], v[44:47]
    v_mfma_f32_16x16x32_bf16 a[192:195], a[108:111], v[140:143], a[192:195]
    v_mfma_f32_16x16x32_bf16 a[196:199], a[172:175], v[140:143], a[196:199]
    v_mfma_f32_16x16x32_bf16 v[40:43], a[48:51], v[144:147], v[40:43]
    buffer_load_dwordx4 v[156:159], v6, s[36:39], s59 offen offset:1024 sc1
    v_mfma_f32_16x16x32_bf16 v[44:47], a[112:115], v[144:147], v[44:47]
    v_mfma_f32_16x16x32_bf16 a[192:195], a[176:179], v[144:147], a[192:195]
    v_mfma_f32_16x16x32_bf16 a[196:199], a[52:55], v[144:147], a[196:199]
    v_mfma_f32_16x16x32_bf16 a[192:195], a[56:59], v[148:151], a[192:195]
    buffer_load_dwordx4 v[160:163], v6, s[36:39], s59 offen offset:2048 sc1
    v_mfma_f32_16x16x32_bf16 a[196:199], a[120:123], v[148:151], a[196:199]
    v_mfma_f32_16x16x32_bf16 v[40:43], a[116:119], v[148:151], v[40:43]
    v_mfma_f32_16x16x32_bf16 v[44:47], a[180:183], v[148:151], v[44:47]
    buffer_load_dwordx4 v[164:167], v6, s[36:39], s59 offen offset:3072 sc1
    s_add_u32 s59, s59, 4096
    buffer_load_dwordx4 v[168:171], v6, s[36:39], s59 offen offset:0 sc1
    buffer_load_dwordx4 v[172:175], v6, s[36:39], s59 offen offset:1024 sc1
    buffer_load_dwordx4 v[176:179], v6, s[36:39], s59 offen offset:2048 sc1
    buffer_load_dwordx4 v[180:183], v6, s[36:39], s59 offen offset:3072 sc1
    s_add_u32 s59, s59, 4096
    ds_write_b128 v16, a[192:195] offset:0
    ds_write_b128 v16, a[196:199] offset:1024
    s_waitcnt lgkmcnt(0)
    s_barrier
    ds_read_b128 v[64:67], v19 offset:0
    ds_read_b128 v[68:71], v19 offset:1024
    ds_read_b128 v[72:75], v19 offset:2048
    ds_read_b128 v[76:79], v19 offset:3072
    ds_read_b128 v[80:83], v19 offset:4096
    ds_read_b128 v[84:87], v19 offset:5120
    s_waitcnt lgkmcnt(4)
    v_pk_add_f32 v[40:41], v[40:41], v[64:65]
    v_pk_add_f32 v[42:43], v[42:43], v[66:67]
    v_pk_add_f32 v[44:45], v[44:45], v[68:69]
    v_pk_add_f32 v[46:47], v[46:47], v[70:71]
    s_waitcnt lgkmcnt(2)
    v_pk_add_f32 v[40:41], v[40:41], v[72:73]
    v_pk_add_f32 v[42:43], v[42:43], v[74:75]
    v_pk_add_f32 v[44:45], v[44:45], v[76:77]
    v_pk_add_f32 v[46:47], v[46:47], v[78:79]
    s_waitcnt lgkmcnt(0)
    v_pk_add_f32 v[40:41], v[40:41], v[80:81]
    v_pk_add_f32 v[42:43], v[42:43], v[82:83]
    v_pk_add_f32 v[44:45], v[44:45], v[84:85]
    v_pk_add_f32 v[46:47], v[46:47], v[86:87]
    v_pk_fma_f32 v[40:41], v[40:41], v[56:57], v[24:25]
    v_pk_fma_f32 v[42:43], v[42:43], v[58:59], v[26:27]
    v_pk_fma_f32 v[44:45], v[44:45], v[60:61], v[28:29]
    v_pk_fma_f32 v[46:47], v[46:47], v[62:63], v[30:31]
    v_cvt_pk_bf16_f32 v240, v40, v41
    v_cvt_pk_bf16_f32 v241, v42, v43
    v_cvt_pk_bf16_f32 v242, v44, v45
    v_cvt_pk_bf16_f32 v243, v46, v47
    buffer_store_dwordx4 v[240:243], v20, s[32:35], 0 offen
    s_waitcnt vmcnt(8)
    v_mfma_f32_16x16x32_bf16 a[200:203], a[0:3], v[152:155], 0
    buffer_load_dwordx4 v[184:187], v6, s[36:39], s59 offen offset:0 sc1
    v_mfma_f32_16x16x32_bf16 a[204:207], a[64:67], v[152:155], 0
    v_mfma_f32_16x16x32_bf16 a[208:211], a[128:131], v[152:155], 0
    v_mfma_f32_16x16x32_bf16 a[212:215], a[4:7], v[152:155], 0
    s_waitcnt vmcnt(8)
    v_mfma_f32_16x16x32_bf16 a[200:203], a[68:71], v[156:159], a[200:203]
    buffer_load_dwordx4 v[188:191], v6, s[36:39], s59 offen offset:1024 sc1
    v_mfma_f32_16x16x32_bf16 a[204:207], a[132:135], v[156:159], a[204:207]
    v_mfma_f32_16x16x32_bf16 a[208:211], a[8:11], v[156:159], a[208:211]
    v_mfma_f32_16x16x32_bf16 a[212:215], a[72:75], v[156:159], a[212:215]
    s_waitcnt vmcnt(8)
    v_mfma_f32_16x16x32_bf16 a[200:203], a[136:139], v[160:163], a[200:203]
    s_add_u32 s59, s59, s25
    buffer_load_dwordx4 v[192:195], v6, s[36:39], s59 offen offset:2048 sc1
    v_mfma_f32_16x16x32_bf16 a[204:207], a[12:15], v[160:163], a[204:207]
    v_mfma_f32_16x16x32_bf16 a[208:211], a[76:79], v[160:163], a[208:211]
    v_mfma_f32_16x16x32_bf16 a[212:215], a[140:143], v[160:163], a[212:215]
    s_waitcnt vmcnt(8)
    v_mfma_f32_16x16x32_bf16 a[200:203], a[16:19], v[164:167], a[200:203]
    s_xor_b32 s59, s75, 0
    s_lshl_b32 s55, s72, 2
    s_add_u32 s59, s59, s55
    s_mul_i32 s59, s59, 44032
    s_add_u32 s59, s59, s24
    s_add_u32 s59, s59, 88064
    buffer_load_dwordx4 v[196:199], v6, s[36:39], s59 offen offset:0 sc1
    v_mfma_f32_16x16x32_bf16 a[204:207], a[80:83], v[164:167], a[204:207]
    v_mfma_f32_16x16x32_bf16 a[208:211], a[144:147], v[164:167], a[208:211]
    v_mfma_f32_16x16x32_bf16 a[212:215], a[20:23], v[164:167], a[212:215]
    s_waitcnt vmcnt(8)
    v_mfma_f32_16x16x32_bf16 a[200:203], a[84:87], v[168:171], a[200:203]
    buffer_load_dwordx4 v[200:203], v6, s[36:39], s59 offen offset:1024 sc1
    v_mfma_f32_16x16x32_bf16 a[204:207], a[148:151], v[168:171], a[204:207]
    v_mfma_f32_16x16x32_bf16 a[208:211], a[24:27], v[168:171], a[208:211]
    v_mfma_f32_16x16x32_bf16 a[212:215], a[88:91], v[168:171], a[212:215]
    s_waitcnt vmcnt(8)
    v_mfma_f32_16x16x32_bf16 a[200:203], a[152:155], v[172:175], a[200:203]
    buffer_load_dwordx4 v[204:207], v6, s[36:39], s59 offen offset:2048 sc1
    v_mfma_f32_16x16x32_bf16 a[204:207], a[28:31], v[172:175], a[204:207]
    v_mfma_f32_16x16x32_bf16 a[208:211], a[92:95], v[172:175], a[208:211]
    v_mfma_f32_16x16x32_bf16 a[212:215], a[156:159], v[172:175], a[212:215]
    s_waitcnt vmcnt(8)
    v_mfma_f32_16x16x32_bf16 a[200:203], a[32:35], v[176:179], a[200:203]
    buffer_load_dwordx4 v[208:211], v6, s[36:39], s59 offen offset:3072 sc1
    s_add_u32 s59, s59, 4096
    v_mfma_f32_16x16x32_bf16 a[204:207], a[96:99], v[176:179], a[204:207]
    v_mfma_f32_16x16x32_bf16 a[208:211], a[160:163], v[176:179], a[208:211]
    v_mfma_f32_16x16x32_bf16 a[212:215], a[36:39], v[176:179], a[212:215]
    s_waitcnt vmcnt(8)
    v_mfma_f32_16x16x32_bf16 a[200:203], a[100:103], v[180:183], a[200:203]
    buffer_load_dwordx4 v[212:215], v6, s[36:39], s59 offen offset:0 sc1
    v_mfma_f32_16x16x32_bf16 a[204:207], a[164:167], v[180:183], a[204:207]
    v_mfma_f32_16x16x32_bf16 a[208:211], a[40:43], v[180:183], a[208:211]
    v_mfma_f32_16x16x32_bf16 a[212:215], a[104:107], v[180:183], a[212:215]
    s_waitcnt vmcnt(7)
    v_mfma_f32_16x16x32_bf16 a[200:203], a[168:171], v[184:187], a[200:203]
    buffer_load_dwordx4 v[216:219], v6, s[36:39], s59 offen offset:1024 sc1
    v_mfma_f32_16x16x32_bf16 a[204:207], a[44:47], v[184:187], a[204:207]
    v_mfma_f32_16x16x32_bf16 a[208:211], a[108:111], v[184:187], a[208:211]
    v_mfma_f32_16x16x32_bf16 a[212:215], a[172:175], v[184:187], a[212:215]
    s_waitcnt vmcnt(7)
    v_mfma_f32_16x16x32_bf16 a[200:203], a[48:51], v[188:191], a[200:203]
    buffer_load_dwordx4 v[220:223], v6, s[36:39], s59 offen offset:2048 sc1
    v_mfma_f32_16x16x32_bf16 a[204:207], a[112:115], v[188:191], a[204:207]
    v_mfma_f32_16x16x32_bf16 a[208:211], a[176:179], v[188:191], a[208:211]
    v_mfma_f32_16x16x32_bf16 a[212:215], a[52:55], v[188:191], a[212:215]
    s_waitcnt vmcnt(7)
    v_mfma_f32_16x16x32_bf16 a[200:203], a[116:119], v[192:195], a[200:203]
    buffer_load_dwordx4 v[224:227], v6, s[36:39], s59 offen offset:3072 sc1
    s_add_u32 s59, s59, 4096
    v_mfma_f32_16x16x32_bf16 a[204:207], a[180:183], v[192:195], a[204:207]
    v_mfma_f32_16x16x32_bf16 a[208:211], a[56:59], v[192:195], a[208:211]
    v_mfma_f32_16x16x32_bf16 a[212:215], a[120:123], v[192:195], a[212:215]
    s_waitcnt vmcnt(7)
    v_mfma_f32_16x16x32_bf16 v[40:43], a[0:3], v[196:199], 0
    buffer_load_dwordx4 v[228:231], v6, s[36:39], s59 offen offset:0 sc1
    v_mfma_f32_16x16x32_bf16 v[44:47], a[64:67], v[196:199], 0
    v_mfma_f32_16x16x32_bf16 a[192:195], a[128:131], v[196:199], 0
    v_mfma_f32_16x16x32_bf16 a[196:199], a[4:7], v[196:199], 0
    s_waitcnt vmcnt(7)
    v_mfma_f32_16x16x32_bf16 v[40:43], a[68:71], v[200:203], v[40:43]
    buffer_load_dwordx4 v[232:235], v6, s[36:39], s59 offen offset:1024 sc1
    v_mfma_f32_16x16x32_bf16 v[44:47], a[132:135], v[200:203], v[44:47]
    v_mfma_f32_16x16x32_bf16 a[192:195], a[8:11], v[200:203], a[192:195]
    v_mfma_f32_16x16x32_bf16 a[196:199], a[72:75], v[200:203], a[196:199]
    s_waitcnt vmcnt(7)
    v_mfma_f32_16x16x32_bf16 v[40:43], a[136:139], v[204:207], v[40:43]
    s_add_u32 s59, s59, s25
    buffer_load_dwordx4 v[236:239], v6, s[36:39], s59 offen offset:2048 sc1
    ds_write_b128 v17, a[200:203] offset:24576
    v_mfma_f32_16x16x32_bf16 v[44:47], a[12:15], v[204:207], v[44:47]
    ds_write_b128 v17, a[204:207] offset:25600
    v_mfma_f32_16x16x32_bf16 a[192:195], a[76:79], v[204:207], a[192:195]
    ds_write_b128 v18, a[208:211] offset:24576
    v_mfma_f32_16x16x32_bf16 a[196:199], a[140:143], v[204:207], a[196:199]
    ds_write_b128 v18, a[212:215] offset:25600
    s_waitcnt vmcnt(7)
    v_mfma_f32_16x16x32_bf16 v[40:43], a[16:19], v[208:211], v[40:43]
    v_mfma_f32_16x16x32_bf16 v[44:47], a[80:83], v[208:211], v[44:47]
    v_mfma_f32_16x16x32_bf16 a[192:195], a[144:147], v[208:211], a[192:195]
    v_mfma_f32_16x16x32_bf16 a[196:199], a[20:23], v[208:211], a[196:199]
    s_waitcnt vmcnt(6)
    v_mfma_f32_16x16x32_bf16 v[40:43], a[84:87], v[212:215], v[40:43]
    v_mfma_f32_16x16x32_bf16 v[44:47], a[148:151], v[212:215], v[44:47]
    v_mfma_f32_16x16x32_bf16 a[192:195], a[24:27], v[212:215], a[192:195]
    v_mfma_f32_16x16x32_bf16 a[196:199], a[88:91], v[212:215], a[196:199]
    s_waitcnt vmcnt(5)
    v_mfma_f32_16x16x32_bf16 v[40:43], a[152:155], v[216:219], v[40:43]
    v_mfma_f32_16x16x32_bf16 v[44:47], a[28:31], v[216:219], v[44:47]
    v_mfma_f32_16x16x32_bf16 a[192:195], a[92:95], v[216:219], a[192:195]
    v_mfma_f32_16x16x32_bf16 a[196:199], a[156:159], v[216:219], a[196:199]
    s_waitcnt vmcnt(4)
    v_mfma_f32_16x16x32_bf16 v[40:43], a[32:35], v[220:223], v[40:43]
    v_mfma_f32_16x16x32_bf16 v[44:47], a[96:99], v[220:223], v[44:47]
    v_mfma_f32_16x16x32_bf16 a[192:195], a[160:163], v[220:223], a[192:195]
    v_mfma_f32_16x16x32_bf16 a[196:199], a[36:39], v[220:223], a[196:199]
    s_waitcnt vmcnt(3)
    v_mfma_f32_16x16x32_bf16 v[40:43], a[100:103], v[224:227], v[40:43]
    v_mfma_f32_16x16x32_bf16 v[44:47], a[164:167], v[224:227], v[44:47]
    v_mfma_f32_16x16x32_bf16 a[192:195], a[40:43], v[224:227], a[192:195]
    v_mfma_f32_16x16x32_bf16 a[196:199], a[104:107], v[224:227], a[196:199]
    s_waitcnt vmcnt(2)
    v_mfma_f32_16x16x32_bf16 v[40:43], a[168:171], v[228:231], v[40:43]
    v_mfma_f32_16x16x32_bf16 v[44:47], a[44:47], v[228:231], v[44:47]
    v_mfma_f32_16x16x32_bf16 a[192:195], a[108:111], v[228:231], a[192:195]
    v_mfma_f32_16x16x32_bf16 a[196:199], a[172:175], v[228:231], a[196:199]
    s_waitcnt vmcnt(1)
    v_mfma_f32_16x16x32_bf16 v[40:43], a[48:51], v[232:235], v[40:43]
    v_mfma_f32_16x16x32_bf16 v[44:47], a[112:115], v[232:235], v[44:47]
    v_mfma_f32_16x16x32_bf16 a[192:195], a[176:179], v[232:235], a[192:195]
    v_mfma_f32_16x16x32_bf16 a[196:199], a[52:55], v[232:235], a[196:199]
    s_waitcnt vmcnt(0)
    v_mfma_f32_16x16x32_bf16 a[192:195], a[56:59], v[236:239], a[192:195]
    v_mfma_f32_16x16x32_bf16 a[196:199], a[120:123], v[236:239], a[196:199]
    v_mfma_f32_16x16x32_bf16 v[40:43], a[116:119], v[236:239], v[40:43]
    v_mfma_f32_16x16x32_bf16 v[44:47], a[180:183], v[236:239], v[44:47]
    s_nop 4
    ds_write_b128 v16, a[192:195] offset:24576
    ds_write_b128 v16, a[196:199] offset:25600
    s_waitcnt lgkmcnt(0)
    s_barrier
    ds_read_b128 v[152:155], v19 offset:24576
    ds_read_b128 v[156:159], v19 offset:25600
    ds_read_b128 v[160:163], v19 offset:26624
    ds_read_b128 v[164:167], v19 offset:27648
    ds_read_b128 v[168:171], v19 offset:28672
    ds_read_b128 v[172:175], v19 offset:29696
    s_waitcnt lgkmcnt(4)
    v_pk_add_f32 v[40:41], v[40:41], v[152:153]
    v_pk_add_f32 v[42:43], v[42:43], v[154:155]
    v_pk_add_f32 v[44:45], v[44:45], v[156:157]
    v_pk_add_f32 v[46:47], v[46:47], v[158:159]
    s_waitcnt lgkmcnt(2)
    v_pk_add_f32 v[40:41], v[40:41], v[160:161]
    v_pk_add_f32 v[42:43], v[42:43], v[162:163]
    v_pk_add_f32 v[44:45], v[44:45], v[164:165]
    v_pk_add_f32 v[46:47], v[46:47], v[166:167]
    s_waitcnt lgkmcnt(0)
    v_pk_add_f32 v[40:41], v[40:41], v[168:169]
    v_pk_add_f32 v[42:43], v[42:43], v[170:171]
    v_pk_add_f32 v[44:45], v[44:45], v[172:173]
    v_pk_add_f32 v[46:47], v[46:47], v[174:175]
    v_pk_fma_f32 v[40:41], v[40:41], v[56:57], v[32:33]
    v_pk_fma_f32 v[42:43], v[42:43], v[58:59], v[34:35]
    v_pk_fma_f32 v[44:45], v[44:45], v[60:61], v[36:37]
    v_pk_fma_f32 v[46:47], v[46:47], v[62:63], v[38:39]
    v_cvt_pk_bf16_f32 v244, v40, v41
    v_cvt_pk_bf16_f32 v245, v42, v43
    v_cvt_pk_bf16_f32 v246, v44, v45
    v_cvt_pk_bf16_f32 v247, v46, v47
    s_mov_b32 s54, 131072
    buffer_store_dwordx4 v[244:247], v20, s[32:35], s54 offen
    s_endpgm
L_nslow_5:
    v_mov_b32 v4, 0
    s_mov_b32 s61, 0
L_spin_35:
    global_load_dword v47, v4, s[46:47] sc1
    s_waitcnt vmcnt(0)
    v_cmp_eq_u32 vcc, 0, v47
    s_cbranch_vccz L_done_36
    s_mov_b64 exec, vcc
    s_sleep 1
    s_add_u32 s61, s61, 1
    s_cmp_lt_u32 s61, 100000
    s_cbranch_scc1 L_spin_35
L_done_36:
    s_mov_b64 exec, -1
    v_readfirstlane_b32 s52, v47
    s_nop 4
    s_branch L_nok_4
L_p1_8:
    buffer_load_dwordx2 v[72:73], v22, s[36:39], s83 offen sc1
    s_waitcnt vmcnt(0)
    v_xor_b32 v72, s52, v72
    v_xor_b32 v73, s44, v73
    v_or_b32 v72, v72, v73
    v_cmp_ne_u32 vcc, 0, v72
    s_cbranch_vccz L_p1re_37
L_p1c_10:
    s_add_u32 s61, s61, 1
    s_cmp_lt_u32 s61, 8
    s_cbranch_scc1 L_p1_8
    s_cmp_ge_u32 s61, 100000
    s_cbranch_scc1 L_p1d_9
    s_add_u32 s56, s83, 262144
    buffer_load_dwordx2 v[74:75], v22, s[36:39], s56 offen sc1
    s_waitcnt vmcnt(0)
    v_cmp_eq_u32 s[62:63], s52, v74
    v_cmp_ne_u32 vcc, s44, v75
    s_sleep 1
    s_and_b64 vcc, vcc, s[62:63]
    s_cbranch_scc0 L_p1_8
    s_mov_b32 s45, 1
    buffer_store_dwordx4 v[170:173], v55, s[36:39], 0 offen sc1
    buffer_store_dwordx4 v[198:201], v57, s[36:39], 0 offen offset:0 sc1
    buffer_store_dwordx4 v[174:177], v56, s[36:39], 0 offen sc1
    buffer_store_dwordx4 v[202:205], v57, s[36:39], 0 offen offset:64 sc1
    s_mov_b32 exec_lo, 0x00010001
    s_mov_b32 exec_hi, 0x00010001
    buffer_store_dwordx4 v[30:33], v63, s[36:39], 0 offen sc1
    s_mov_b64 exec, -1
    s_waitcnt vmcnt(0)
    s_mov_b64 exec, 1
    v_mov_b32 v4, 156952
    v_mov_b32 v5, 1
    ds_add_rtn_u32 v5, v4, v5
    s_lshl_b32 s54, s3, 7
    s_add_u32 s54, s54, 327680
    v_mov_b32 v4, s52
    s_waitcnt lgkmcnt(0)
    v_readfirstlane_b32 s55, v5
    v_mov_b32 v5, s44
    s_cmp_lg_u32 s55, 3
    s_cbranch_scc1 L_sig_38
    buffer_store_dword v4, v1, s[36:39], s54 offen sc1
L_sig_38:
    s_mov_b64 exec, -1
    s_add_u32 s56, s83, 327680
    s_mov_b32 s61, 0
L_spin_39:
    buffer_load_dword v72, v22, s[36:39], s56 offen sc1
    s_waitcnt vmcnt(0)
    v_cmp_ne_u32 vcc, s52, v72
    s_cbranch_vccz L_done_40
    s_mov_b64 exec, vcc
    s_sleep 1
    s_add_u32 s61, s61, 1
    s_cmp_lt_u32 s61, 100000
    s_cbranch_scc1 L_spin_39
L_done_40:
    s_mov_b64 exec, -1
L_p1re_37:
    buffer_load_dwordx4 v[238:241], v23, s[36:39], s82 offen sc1
    buffer_load_dwordx4 v[242:245], v23, s[36:39], s82 offen offset:1024 sc1
    s_waitcnt vmcnt(0)
    s_branch L_p1d_9
L_slow_13:
    s_mov_b64 exec, vcc
    s_sleep 4
    s_mov_b32 s61, 0
L_spin_41:
    s_mov_b32 s56, 49152
    buffer_load_dwordx4 v[40:43], v6, s[36:39], s56 offen sc1
    s_waitcnt vmcnt(0)
    v_xor_b32 v40, s52, v40
    v_xor_b32 v41, s52, v41
    v_xor_b32 v42, s52, v42
    v_xor_b32 v43, s52, v43
    v_or3_b32 v40, v40, v41, v42
    v_or_b32 v40, v40, v43
    v_cmp_ne_u32 vcc, 0, v40
    s_cbranch_vccz L_done_42
    s_mov_b64 exec, vcc
    s_sleep 4
    s_add_u32 s61, s61, 1
    s_cmp_lt_u32 s61, 100000
    s_cbranch_scc1 L_spin_41
L_done_42:
    s_mov_b64 exec, -1
    s_nop 4
    s_branch L_back_14
L_slow_15:
    s_cmp_lg_u32 s45, 0
    s_cbranch_scc1 L_back_16
    s_mov_b64 exec, vcc
    s_mov_b32 s61, 0
L_spin_43:
    s_add_u32 s56, s83, 294912
    buffer_load_dwordx2 v[44:45], v22, s[36:39], s56 offen sc1
    s_waitcnt vmcnt(0)
    v_xor_b32 v44, s52, v44
    v_xor_b32 v45, s44, v45
    v_or_b32 v44, v44, v45
    v_cmp_ne_u32 vcc, 0, v44
    s_cbranch_vccz L_done_44
    s_mov_b64 exec, vcc
    s_sleep 1
    s_add_u32 s61, s61, 1
    s_cmp_lt_u32 s61, 100000
    s_cbranch_scc1 L_spin_43
L_done_44:
    s_mov_b64 exec, -1
    s_nop 4
    s_branch L_back_16
L_slow_19:
    s_mov_b64 exec, vcc
    s_sleep 4
    s_mov_b32 s61, 0
L_spin_45:
    s_mov_b32 s56, 32768
    buffer_load_dwordx4 v[40:43], v6, s[36:39], s56 offen sc1
    s_waitcnt vmcnt(0)
    v_xor_b32 v40, s52, v40
    v_xor_b32 v41, s52, v41
    v_xor_b32 v42, s52, v42
    v_xor_b32 v43, s52, v43
    v_or3_b32 v40, v40, v41, v42
    v_or_b32 v40, v40, v43
    v_cmp_ne_u32 vcc, 0, v40
    s_cbranch_vccz L_done_46
    s_mov_b64 exec, vcc
    s_sleep 4
    s_add_u32 s61, s61, 1
    s_cmp_lt_u32 s61, 100000
    s_cbranch_scc1 L_spin_45
L_done_46:
    s_mov_b64 exec, -1
    s_nop 4
    s_branch L_back_20
L_slow_27:
    s_mov_b64 exec, vcc
    s_mov_b32 s61, 0
L_spin_47:
    s_mov_b32 s56, 40960
    buffer_load_dwordx4 v[252:255], v6, s[36:39], s56 offen sc1
    s_waitcnt vmcnt(0)
    v_xor_b32 v252, s52, v252
    v_xor_b32 v253, s52, v253
    v_xor_b32 v254, s52, v254
    v_xor_b32 v255, s52, v255
    v_or3_b32 v252, v252, v253, v254
    v_or_b32 v252, v252, v255
    v_cmp_ne_u32 vcc, 0, v252
    s_cbranch_vccz L_done_48
    s_mov_b64 exec, vcc
    s_sleep 2
    s_add_u32 s61, s61, 1
    s_cmp_lt_u32 s61, 100000
    s_cbranch_scc1 L_spin_47
L_done_48:
    s_mov_b64 exec, -1
    s_nop 4
    s_branch L_back_28
L_slow_31:
    s_mov_b64 exec, vcc
    s_mov_b32 s61, 0
L_spin_49:
    buffer_load_dwordx4 v[248:251], v10, s[36:39], s60 offen offset:0 sc1
    s_waitcnt vmcnt(0)
    v_xor_b32 v248, s52, v248
    v_xor_b32 v249, s52, v249
    v_xor_b32 v250, s52, v250
    v_xor_b32 v251, s52, v251
    v_or3_b32 v248, v248, v249, v250
    v_or_b32 v248, v248, v251
    v_cmp_ne_u32 vcc, 0, v248
    s_cbranch_vccz L_done_50
    s_mov_b64 exec, vcc
    s_sleep 1
    s_add_u32 s61, s61, 1
    s_cmp_lt_u32 s61, 100000
    s_cbranch_scc1 L_spin_49
L_done_50:
    s_mov_b64 exec, -1
    s_nop 4
    s_branch L_back_32
L_slow_33:
    s_mov_b64 exec, vcc
    s_mov_b32 s61, 0
L_spin_51:
    buffer_load_dwordx4 v[248:251], v10, s[36:39], s60 offen offset:16 sc1
    s_waitcnt vmcnt(0)
    v_xor_b32 v248, s52, v248
    v_xor_b32 v249, s52, v249
    v_xor_b32 v250, s52, v250
    v_xor_b32 v251, s52, v251
    v_or3_b32 v248, v248, v249, v250
    v_or_b32 v248, v248, v251
    v_cmp_ne_u32 vcc, 0, v248
    s_cbranch_vccz L_done_52
    s_mov_b64 exec, vcc
    s_sleep 1
    s_add_u32 s61, s61, 1
    s_cmp_lt_u32 s61, 100000
    s_cbranch_scc1 L_spin_51
L_done_52:
    s_mov_b64 exec, -1
    s_nop 4
    s_branch L_back_34
L_exit:
    s_endpgm
.section .rodata,"a"
.p2align 6
.amdhsa_kernel adaLN_cond__ssm_conv_h3__dense_activation_relu__prompt_kernel
  .amdhsa_next_free_vgpr 512
  .amdhsa_next_free_sgpr 102
  .amdhsa_accum_offset 256
  .amdhsa_group_segment_fixed_size 0
  .amdhsa_kernarg_size 112
  .amdhsa_user_sgpr_count 2
  .amdhsa_user_sgpr_kernarg_segment_ptr 1
  .amdhsa_system_sgpr_workgroup_id_x 1
.end_amdhsa_kernel
```
